```python
import torch

def _softmax(x, axis=-1):
    return torch.softmax(x, dim=axis)
def _gelu(x):
    return torch.nn.functional.gelu(x, approximate="tanh")
def _silu(x):
    return torch.nn.functional.silu(x)
def _sigmoid(x):
    return torch.sigmoid(x)
def _layernorm(x, axis=-1, eps=1e-5):
    m = x.mean(dim=axis, keepdim=True)
    v = x.var(dim=axis, keepdim=True, unbiased=False)
    return (x - m) / torch.sqrt(v + eps)
def _scatter_add(tgt, idx, src, axis=0):
    return tgt.clone().index_add_(axis, idx, src)
def _segment_sum(src, seg, n):
    out = torch.zeros((n,) + src.shape[1:], dtype=src.dtype)
    return out.index_add_(0, seg, src)
def _pad(x, pw):
    flat = tuple(v for pair in reversed(pw) for v in pair)
    return torch.nn.functional.pad(x, flat)

kernel_name = 'concat_heads__ssm_conv_s5__linear_attn_block__prompt'

def setup_inputs():

    _w = (lambda a: (lambda t: t.to(torch.bfloat16) if t.is_floating_point() else t)(torch.as_tensor(a)))
    def _A_setup():
        B, S, D = 1, 2048, 512
        P = D
        Lambda_re = -0.5 * (lambda _x: torch.exp(torch.as_tensor(_x)))((lambda *s: torch.randn(*s, dtype=torch.bfloat16) * 0.2)(P))
        Lambda_im = (lambda *s: torch.randn(*s, dtype=torch.bfloat16) * 0.8)(P) * 1.0
        B_re = (lambda *s: torch.randn(*s, dtype=torch.bfloat16) * 0.2)(P, D) * (D ** -0.5)
        B_im = (lambda *s: torch.randn(*s, dtype=torch.bfloat16) * 0.2)(P, D) * (D ** -0.5)
        C_re = (lambda *s: torch.randn(*s, dtype=torch.bfloat16) * 0.2)(D, P) * (P ** -0.5)
        C_im = (lambda *s: torch.randn(*s, dtype=torch.bfloat16) * 0.2)(D, P) * (P ** -0.5)
        log_dt = (lambda *s: torch.randn(*s, dtype=torch.bfloat16) * 0.2)(P) * 0.3 - 2.0
        Dskip = (lambda *s: torch.randn(*s, dtype=torch.bfloat16) * 0.05)(D)
        return {
            "x": _w((lambda *s: torch.randn(*s, dtype=torch.bfloat16) * 0.05)(B, S, D)),
            "Lambda_re": _w(Lambda_re),
            "Lambda_im": _w(Lambda_im),
            "B_re": _w(B_re),
            "B_im": _w(B_im),
            "C_re": _w(C_re),
            "C_im": _w(C_im),
            "log_dt": _w(log_dt),
            "Dskip": _w(Dskip),
        }
    _A_in = _A_setup()

    def _B_setup():
        B, S, D = 1, 2048, 512
        return {
            "x": _w((lambda *s: torch.randn(*s, dtype=torch.bfloat16) * 0.05)(B, S, D)),
            "wqkv": _w((lambda *s: torch.randn(*s, dtype=torch.bfloat16) * 0.4)(D, 3 * D)),
            "wo": _w((lambda *s: torch.randn(*s, dtype=torch.bfloat16) * 0.05)(D, D)),
        }
    _B_in = _B_setup()

    return {
        "A_x": _A_in["x"],
        "A_Lambda_re": _A_in["Lambda_re"],
        "A_Lambda_im": _A_in["Lambda_im"],
        "A_B_re": _A_in["B_re"],
        "A_B_im": _A_in["B_im"],
        "A_C_re": _A_in["C_re"],
        "A_C_im": _A_in["C_im"],
        "A_log_dt": _A_in["log_dt"],
        "A_Dskip": _A_in["Dskip"],
        "B_x": _B_in["x"],
        "B_wqkv": _B_in["wqkv"],
        "B_wo": _B_in["wo"],
    }

def reference(A_x, A_Lambda_re, A_Lambda_im, A_B_re, A_B_im, A_C_re, A_C_im, A_log_dt, A_Dskip, B_x, B_wqkv, B_wo):
    def _A_ref(x, Lambda_re, Lambda_im, B_re, B_im, C_re, C_im, log_dt, Dskip):
        Bsz, L, H = x.shape
        Lam = Lambda_re + 1j * Lambda_im
        Bmat = B_re + 1j * B_im
        Cmat = C_re + 1j * C_im
        dt = torch.exp(log_dt)
        Lam_bar = torch.exp(dt * Lam)
        B_bar = ((Lam_bar - 1.0) / Lam)[:, None] * Bmat
        Bu = torch.einsum("bld,pd->blp", x + 0j, B_bar)
        h = torch.zeros_like(Bu[:, 0, :])
        hs = []
        for t in range(L):
            h = Lam_bar[None, :] * h + Bu[:, t, :]
            hs.append(h)
        hseq = torch.stack(hs, 1)
        y = 2.0 * torch.einsum("blp,dp->bld", hseq, Cmat).real + x * Dskip[None, None, :]
        return y

    def _B_ref(x, wqkv, wo):
        B, S, D = x.shape
        H = 32; Dh = D // H
        qkv = (lambda x, *d: x.permute(*d))((x @ wqkv).reshape(B, S, 3, H, Dh), 2, 0, 3, 1, 4)
        q, k, v = qkv[0], qkv[1], qkv[2]
        phi = lambda t: torch.where(t > 0, t + 1, torch.exp(t)) + 1e-6
        pq, pk = phi(q), phi(k)
        kv = torch.einsum("bhsd,bhse->bhde", pk, v)
        z = torch.einsum("bhsd->bhd", pk)
        num = torch.einsum("bhqd,bhde->bhqe", pq, kv)
        den = torch.einsum("bhqd,bhd->bhq", pq, z)[..., None] + 1e-6
        o = num / den
        return (lambda x, *d: x.permute(*d))(o, 0, 2, 1, 3).reshape(B, S, D) @ wo

    a = _A_ref(A_x, A_Lambda_re, A_Lambda_im, A_B_re, A_B_im, A_C_re, A_C_im, A_log_dt, A_Dskip)
    b = _B_ref(B_x, B_wqkv, B_wo)
    return torch.concatenate([a, b], axis=-1)
```

```asm
; @launch kernel=s5la_f1_kernel grid=(256,1,1) block=(512,1,1) lds=163840
.amdgcn_target "amdgcn-amd-amdhsa--gfx950"
.text
.globl s5la_f1_kernel
.type s5la_f1_kernel,@function
.p2align 8
s5la_f1_kernel:
    s_cmp_ge_u32 s2, 256
    s_cbranch_scc1 K1_END0
    s_load_dwordx4 s[24:27], s[0:1], 0
    s_load_dwordx4 s[28:31], s[0:1], 16
    s_load_dwordx2 s[32:33], s[0:1], 32
    s_load_dwordx2 s[34:35], s[0:1], 56
    s_load_dwordx4 s[36:39], s[0:1], 72
    s_load_dwordx4 s[60:63], s[0:1], 104
    s_getpc_b64 s[70:71]
K1_PC:
    v_lshrrev_b32 v1, 6, v0
    v_and_b32 v2, 63, v0
    s_lshr_b32 s72, s2, 3
    v_lshl_add_u32 v3, s72, 3, v1
    v_mul_u32_u24 v4, 1681, v3
    v_lshrrev_b32 v4, 16, v4
    v_mul_u32_u24 v4, 39, v4
    v_sub_u32 v3, v3, v4
    v_max_i32 v3, 0, v3
    v_lshlrev_b32 v3, 10, v3
    v_lshl_add_u32 v3, v2, 4, v3
    s_and_b32 s70, s70, 0xffffff00
    v_min_u32 v3, CODE_END-s5la_f1_kernel-16, v3
    global_load_dwordx4 v[252:255], v3, s[70:71]
    s_mov_b32 s50, 0x3fb8aa3b
    s_mov_b32 s51, 0x358637bd
    v_readfirstlane_b32 s3, v1
    s_and_b32 s6, s2, 7
    s_lshr_b32 s7, s2, 3
    s_xor_b32 s6, s6, 4
    s_lshl_b32 s4, s6, 2
    s_and_b32 s42, s7, 3
    s_or_b32 s4, s4, s42
    s_lshr_b32 s5, s7, 2
    s_and_b32 s42, s6, 1
    s_lshl_b32 s42, s42, 3
    s_and_b32 s43, s7, 7
    s_or_b32 s42, s42, s43
    s_and_b32 s43, s6, 2
    s_lshl_b32 s43, s43, 1
    s_lshr_b32 s44, s7, 3
    s_or_b32 s43, s43, s44
    s_lshr_b32 s73, s6, 2
    s_cmp_ge_u32 s73, 1
    s_cselect_b32 s4, s42, s4
    s_cselect_b32 s5, s43, s5
    s_mov_b32 s14, 0x80000
    s_cselect_b32 s14, 0x180000, s14
    s_waitcnt lgkmcnt(0)
    s_cselect_b32 s8, s36, s24
    s_cselect_b32 s9, s37, s25
    s_cselect_b32 s12, s38, s30
    s_cselect_b32 s13, s39, s31
    s_and_b32 s9, s9, 0xffff
    s_and_b32 s13, s13, 0xffff
    s_mov_b32 s10, 0x200000
    s_mov_b32 s11, 0x00020000
    s_mov_b32 s15, 0x00020000
    s_mov_b32 s16, s32
    s_and_b32 s17, s33, 0xffff
    s_mov_b32 s18, 0x80000
    s_mov_b32 s19, 0x00020000
    s_mov_b32 s20, s62
    s_and_b32 s21, s63, 0xffff
    s_mov_b32 s22, 0x10000000
    s_mov_b32 s23, 0x00020000
    s_mov_b32 s56, s60
    s_and_b32 s57, s61, 0xffff
    s_mov_b32 s58, 0x100
    s_mov_b32 s59, 0x00020000
    s_lshl_b32 s42, s73, 8
    s_load_dword s40, s[62:63], s42 offset:0x20000
    s_cmp_lt_u32 s3, 4
    s_cbranch_scc1 K1_COMP
    s_cmp_ge_u32 s73, 1
    s_cbranch_scc1 K1_B_LOAD
    s_lshr_b32 s49, s7, 3
    s_add_u32 s49, s49, s7
    s_mov_b32 s41, s7
    s_sub_u32 s7, s3, 4
    v_lshrrev_b32 v3, 3, v2
    v_and_b32 v4, 7, v2
    v_lshrrev_b32 v5, 4, v2
    s_lshl_b32 s42, s4, 7
    s_lshl_b32 s43, s7, 5
    s_add_u32 s42, s42, s43
    v_add_u32 v7, s42, v3
    v_lshlrev_b32 v7, 10, v7
    v_and_b32 v6, 1, v5
    s_lshl_b32 s42, s7, 1
    v_or_b32 v6, s42, v6
    v_xor_b32 v6, v4, v6
    v_lshl_add_u32 v8, v6, 4, v7
    v_mov_b32 v9, v8
    s_lshl_b32 s42, s5, 6
    s_lshl_b32 s43, s7, 4
    s_add_u32 s42, s42, s43
    v_add_u32 v7, s42, v3
    v_lshlrev_b32 v7, 10, v7
    v_xor_b32 v6, v4, v5
    v_lshl_add_u32 v10, v6, 4, v7
    v_xor_b32 v6, 4, v6
    v_add_u32 v7, 0x2000, v7
    v_lshl_add_u32 v11, v6, 4, v7
    s_lshl_b32 s44, s7, 12
    s_add_u32 s45, s44, 16384
    s_lshl_b32 s48, s7, 11
    s_add_u32 s48, s48, 32768
    s_load_dwordx4 s[64:67], s[0:1], 40
    s_load_dwordx2 s[68:69], s[0:1], 88
    s_load_dwordx2 s[74:75], s[0:1], 64
    s_load_dwordx2 s[76:77], s[0:1], 96
    s_add_u32 s47, s49, 0
    s_and_b32 s47, s47, 7
    s_lshl_b32 s42, s47, 7
    s_add_u32 m0, s44, 0
    s_add_u32 s46, s42, 0
    buffer_load_dwordx4 v8, s[8:11], s46 offen lds
    s_add_u32 m0, s44, 1024
    s_add_u32 s46, s42, 8192
    buffer_load_dwordx4 v9, s[8:11], s46 offen lds
    s_add_u32 m0, s44, 2048
    s_add_u32 s46, s42, 16384
    buffer_load_dwordx4 v8, s[8:11], s46 offen lds
    s_add_u32 m0, s44, 3072
    s_add_u32 s46, s42, 24576
    buffer_load_dwordx4 v9, s[8:11], s46 offen lds
    s_add_u32 m0, s45, 0
    buffer_load_dwordx4 v10, s[12:15], s42 offen lds
    s_add_u32 m0, s45, 1024
    buffer_load_dwordx4 v11, s[12:15], s42 offen lds
    s_add_u32 m0, s45, 2048
    buffer_load_dwordx4 v10, s[16:19], s42 offen lds
    s_add_u32 m0, s45, 3072
    buffer_load_dwordx4 v11, s[16:19], s42 offen lds
    s_waitcnt vmcnt(0)
    s_barrier
    s_add_u32 s47, s49, 1
    s_and_b32 s47, s47, 7
    s_lshl_b32 s42, s47, 7
    s_add_u32 m0, s44, 40960
    s_add_u32 s46, s42, 0
    buffer_load_dwordx4 v8, s[8:11], s46 offen lds
    s_add_u32 m0, s44, 41984
    s_add_u32 s46, s42, 8192
    buffer_load_dwordx4 v9, s[8:11], s46 offen lds
    s_add_u32 m0, s44, 43008
    s_add_u32 s46, s42, 16384
    buffer_load_dwordx4 v8, s[8:11], s46 offen lds
    s_add_u32 m0, s44, 44032
    s_add_u32 s46, s42, 24576
    buffer_load_dwordx4 v9, s[8:11], s46 offen lds
    s_add_u32 m0, s45, 40960
    buffer_load_dwordx4 v10, s[12:15], s42 offen lds
    s_add_u32 m0, s45, 41984
    buffer_load_dwordx4 v11, s[12:15], s42 offen lds
    s_add_u32 m0, s45, 43008
    buffer_load_dwordx4 v10, s[16:19], s42 offen lds
    s_add_u32 m0, s45, 44032
    buffer_load_dwordx4 v11, s[16:19], s42 offen lds
    s_add_u32 s47, s49, 2
    s_and_b32 s47, s47, 7
    s_lshl_b32 s42, s47, 7
    s_add_u32 m0, s44, 81920
    s_add_u32 s46, s42, 0
    buffer_load_dwordx4 v8, s[8:11], s46 offen lds
    s_add_u32 m0, s44, 82944
    s_add_u32 s46, s42, 8192
    buffer_load_dwordx4 v9, s[8:11], s46 offen lds
    s_add_u32 m0, s44, 83968
    s_add_u32 s46, s42, 16384
    buffer_load_dwordx4 v8, s[8:11], s46 offen lds
    s_add_u32 m0, s44, 84992
    s_add_u32 s46, s42, 24576
    buffer_load_dwordx4 v9, s[8:11], s46 offen lds
    s_add_u32 m0, s45, 81920
    buffer_load_dwordx4 v10, s[12:15], s42 offen lds
    s_add_u32 m0, s45, 82944
    buffer_load_dwordx4 v11, s[12:15], s42 offen lds
    s_add_u32 m0, s45, 83968
    buffer_load_dwordx4 v10, s[16:19], s42 offen lds
    s_add_u32 m0, s45, 84992
    buffer_load_dwordx4 v11, s[16:19], s42 offen lds
    s_waitcnt vmcnt(8)
    s_barrier
    s_add_u32 s47, s49, 3
    s_and_b32 s47, s47, 7
    s_lshl_b32 s42, s47, 7
    s_add_u32 m0, s44, 122880
    s_add_u32 s46, s42, 0
    buffer_load_dwordx4 v8, s[8:11], s46 offen lds
    s_add_u32 m0, s44, 123904
    s_add_u32 s46, s42, 8192
    buffer_load_dwordx4 v9, s[8:11], s46 offen lds
    s_add_u32 m0, s44, 124928
    s_add_u32 s46, s42, 16384
    buffer_load_dwordx4 v8, s[8:11], s46 offen lds
    s_add_u32 m0, s44, 125952
    s_add_u32 s46, s42, 24576
    buffer_load_dwordx4 v9, s[8:11], s46 offen lds
    s_add_u32 m0, s45, 122880
    buffer_load_dwordx4 v10, s[12:15], s42 offen lds
    s_add_u32 m0, s45, 123904
    buffer_load_dwordx4 v11, s[12:15], s42 offen lds
    s_add_u32 m0, s45, 124928
    buffer_load_dwordx4 v10, s[16:19], s42 offen lds
    s_add_u32 m0, s45, 125952
    buffer_load_dwordx4 v11, s[16:19], s42 offen lds
    s_waitcnt vmcnt(8)
    s_barrier
    s_add_u32 s47, s49, 4
    s_and_b32 s47, s47, 7
    s_lshl_b32 s42, s47, 7
    s_add_u32 m0, s44, 0
    s_add_u32 s46, s42, 0
    buffer_load_dwordx4 v8, s[8:11], s46 offen lds
    s_add_u32 m0, s44, 1024
    s_add_u32 s46, s42, 8192
    buffer_load_dwordx4 v9, s[8:11], s46 offen lds
    s_add_u32 m0, s44, 2048
    s_add_u32 s46, s42, 16384
    buffer_load_dwordx4 v8, s[8:11], s46 offen lds
    s_add_u32 m0, s44, 3072
    s_add_u32 s46, s42, 24576
    buffer_load_dwordx4 v9, s[8:11], s46 offen lds
    s_add_u32 m0, s45, 0
    buffer_load_dwordx4 v10, s[12:15], s42 offen lds
    s_add_u32 m0, s45, 1024
    buffer_load_dwordx4 v11, s[12:15], s42 offen lds
    s_add_u32 m0, s45, 2048
    buffer_load_dwordx4 v10, s[16:19], s42 offen lds
    s_add_u32 m0, s45, 3072
    buffer_load_dwordx4 v11, s[16:19], s42 offen lds
    s_waitcnt vmcnt(8)
    s_barrier
    s_add_u32 s47, s49, 5
    s_and_b32 s47, s47, 7
    s_lshl_b32 s42, s47, 7
    s_add_u32 m0, s44, 40960
    s_add_u32 s46, s42, 0
    buffer_load_dwordx4 v8, s[8:11], s46 offen lds
    s_add_u32 m0, s44, 41984
    s_add_u32 s46, s42, 8192
    buffer_load_dwordx4 v9, s[8:11], s46 offen lds
    s_add_u32 m0, s44, 43008
    s_add_u32 s46, s42, 16384
    buffer_load_dwordx4 v8, s[8:11], s46 offen lds
    s_add_u32 m0, s44, 44032
    s_add_u32 s46, s42, 24576
    buffer_load_dwordx4 v9, s[8:11], s46 offen lds
    s_add_u32 m0, s45, 40960
    buffer_load_dwordx4 v10, s[12:15], s42 offen lds
    s_add_u32 m0, s45, 41984
    buffer_load_dwordx4 v11, s[12:15], s42 offen lds
    s_add_u32 m0, s45, 43008
    buffer_load_dwordx4 v10, s[16:19], s42 offen lds
    s_add_u32 m0, s45, 44032
    buffer_load_dwordx4 v11, s[16:19], s42 offen lds
    s_waitcnt vmcnt(8)
    s_barrier
    s_add_u32 s47, s49, 6
    s_and_b32 s47, s47, 7
    s_lshl_b32 s42, s47, 7
    s_add_u32 m0, s44, 81920
    s_add_u32 s46, s42, 0
    buffer_load_dwordx4 v8, s[8:11], s46 offen lds
    s_add_u32 m0, s44, 82944
    s_add_u32 s46, s42, 8192
    buffer_load_dwordx4 v9, s[8:11], s46 offen lds
    s_add_u32 m0, s44, 83968
    s_add_u32 s46, s42, 16384
    buffer_load_dwordx4 v8, s[8:11], s46 offen lds
    s_add_u32 m0, s44, 84992
    s_add_u32 s46, s42, 24576
    buffer_load_dwordx4 v9, s[8:11], s46 offen lds
    s_add_u32 m0, s45, 81920
    buffer_load_dwordx4 v10, s[12:15], s42 offen lds
    s_add_u32 m0, s45, 82944
    buffer_load_dwordx4 v11, s[12:15], s42 offen lds
    s_add_u32 m0, s45, 83968
    buffer_load_dwordx4 v10, s[16:19], s42 offen lds
    s_add_u32 m0, s45, 84992
    buffer_load_dwordx4 v11, s[16:19], s42 offen lds
    s_waitcnt vmcnt(8)
    s_barrier
    s_add_u32 s47, s49, 7
    s_and_b32 s47, s47, 7
    s_lshl_b32 s42, s47, 7
    s_add_u32 m0, s44, 122880
    s_add_u32 s46, s42, 0
    buffer_load_dwordx4 v8, s[8:11], s46 offen lds
    s_add_u32 m0, s44, 123904
    s_add_u32 s46, s42, 8192
    buffer_load_dwordx4 v9, s[8:11], s46 offen lds
    s_add_u32 m0, s44, 124928
    s_add_u32 s46, s42, 16384
    buffer_load_dwordx4 v8, s[8:11], s46 offen lds
    s_add_u32 m0, s44, 125952
    s_add_u32 s46, s42, 24576
    buffer_load_dwordx4 v9, s[8:11], s46 offen lds
    s_add_u32 m0, s45, 122880
    buffer_load_dwordx4 v10, s[12:15], s42 offen lds
    s_add_u32 m0, s45, 123904
    buffer_load_dwordx4 v11, s[12:15], s42 offen lds
    s_add_u32 m0, s45, 124928
    buffer_load_dwordx4 v10, s[16:19], s42 offen lds
    s_add_u32 m0, s45, 125952
    buffer_load_dwordx4 v11, s[16:19], s42 offen lds
    s_waitcnt lgkmcnt(0)
    s_lshl_b32 s42, s41, 2
    s_add_u32 s42, s42, s7
    s_lshl_b32 s42, s42, 12
    v_lshl_add_u32 v14, v2, 4, s42
    global_load_dwordx4 v[40:43], v14, s[64:65] offset:0
    global_load_dwordx4 v[40:43], v14, s[64:65] offset:1024
    global_load_dwordx4 v[40:43], v14, s[64:65] offset:2048
    global_load_dwordx4 v[40:43], v14, s[64:65] offset:3072
    global_load_dwordx4 v[40:43], v14, s[66:67] offset:0
    global_load_dwordx4 v[40:43], v14, s[66:67] offset:1024
    global_load_dwordx4 v[40:43], v14, s[66:67] offset:2048
    global_load_dwordx4 v[40:43], v14, s[66:67] offset:3072
    s_waitcnt vmcnt(16)
    s_barrier
    s_waitcnt vmcnt(8)
    s_barrier
    s_waitcnt lgkmcnt(0)
    s_add_u32 s26, s40, 1
    s_xor_b32 s27, s26, 0x9e3779b9
    s_mov_b32 s31, 0
    s_and_b32 s28, s6, 3
    s_lshl_b32 s28, s28, 3
    s_and_b32 s42, s41, 7
    s_or_b32 s28, s28, s42
    s_lshr_b32 s29, s41, 3
    s_and_b32 s30, s3, 3
    s_mov_b32 s36, s76
    s_and_b32 s37, s77, 0xffff
    s_mov_b32 s38, 0x800000
    s_mov_b32 s39, 0x00020000
    s_mov_b32 s12, s64
    s_and_b32 s13, s65, 0xffff
    s_mov_b32 s14, 0x80000
    s_mov_b32 s15, 0x00020000
    s_mov_b32 s16, s66
    s_and_b32 s17, s67, 0xffff
    s_mov_b32 s18, 0x80000
    s_mov_b32 s19, 0x00020000
    v_lshrrev_b32 v3, 4, v2
    v_and_b32 v4, 15, v2
    v_lshlrev_b32 v10, 4, v2
    s_lshl_b32 s42, s28, 6
    s_lshl_b32 s43, s31, 4
    s_add_u32 s42, s42, s43
    v_add_u32 v5, s42, v4
    s_lshl_b32 s42, s29, 7
    s_lshl_b32 s43, s30, 5
    s_add_u32 s42, s42, s43
    v_lshl_add_u32 v7, v3, 2, s42
    v_lshlrev_b32 v6, 10, v5
    v_add_u32 v6, v6, v7
    v_lshlrev_b32 v6, 2, v6
    s_lshl_b32 s42, s31, 2
    s_add_u32 s42, s42, s30
    s_lshl_b32 s42, s42, 12
    v_add_u32 v12, s42, v10
    s_xor_b32 s42, s42, 0x4000
    v_add_u32 v11, s42, v10
    s_lshl_b32 s33, s7, 15
    s_add_u32 s33, s33, 32768
    v_lshrrev_b32 v34, 3, v2
    v_and_b32 v35, 7, v2
    v_lshrrev_b32 v33, 1, v34
    v_xor_b32 v35, v35, v33
    s_lshl_b32 s42, s29, 7
    s_lshl_b32 s43, s30, 5
    s_add_u32 s42, s42, s43
    v_add_u32 v34, s42, v34
    v_lshlrev_b32 v34, 10, v34
    v_lshl_add_u32 v32, v35, 4, v34
    v_xor_b32 v35, 4, v35
    v_lshl_add_u32 v33, v35, 4, v34
    v_lshrrev_b32 v34, 1, v4
    v_xor_b32 v34, v34, v3
    v_lshlrev_b32 v35, 7, v4
    v_lshl_add_u32 v34, v34, 4, v35
    v_add_u32 v34, s33, v34
    v_xor_b32 v35, 64, v34
    v_lshrrev_b32 v8, 1, v3
    v_lshlrev_b32 v8, 10, v8
    v_and_b32 v9, 31, v2
    v_lshl_add_u32 v8, v9, 4, v8
    s_lshl_b32 s42, s31, 16
    s_add_u32 s42, s42, 32768
    v_add_u32 v8, s42, v8
    s_lshl_b32 s42, s28, 17
    s_lshl_b32 s43, s7, 13
    s_add_u32 s32, s42, s43
    s_add_u32 s32, s32, 0x400000
    s_lshr_b32 s42, s28, 1
    s_lshl_b32 s42, s42, 2
    s_add_u32 s42, s42, s7
    s_mul_i32 s42, s42, 4352
    s_add_u32 s48, s42, 0x40000
    s_add_u32 s43, s41, s7
    s_add_u32 s42, s43, 0
    s_and_b32 s42, s42, 3
    s_lshl_b32 s54, s42, 7
    s_lshl_b32 s42, s42, 13
    s_add_u32 s44, s42, s33
    s_add_u32 s42, s43, 1
    s_and_b32 s42, s42, 3
    s_lshl_b32 s55, s42, 7
    s_lshl_b32 s42, s42, 13
    s_add_u32 s45, s42, s33
    s_add_u32 s42, s43, 2
    s_and_b32 s42, s42, 3
    s_lshl_b32 s70, s42, 7
    s_lshl_b32 s42, s42, 13
    s_add_u32 s47, s42, s33
    s_add_u32 s42, s43, 3
    s_and_b32 s42, s42, 3
    s_lshl_b32 s71, s42, 7
    s_lshl_b32 s42, s42, 13
    s_add_u32 s49, s42, s33
    s_barrier
    s_add_u32 m0, s44, 0
    s_add_u32 s46, s54, 0
    buffer_load_dwordx4 v32, s[12:15], s46 offen lds
    s_add_u32 m0, s44, 1024
    s_add_u32 s46, s54, 8192
    buffer_load_dwordx4 v33, s[12:15], s46 offen lds
    s_waitcnt vmcnt(6)
    s_add_u32 m0, s44, 2048
    s_add_u32 s46, s54, 16384
    buffer_load_dwordx4 v32, s[12:15], s46 offen lds
    s_add_u32 m0, s44, 3072
    s_add_u32 s46, s54, 24576
    buffer_load_dwordx4 v33, s[12:15], s46 offen lds
    s_waitcnt vmcnt(6)
    s_add_u32 m0, s44, 4096
    s_add_u32 s46, s54, 0
    buffer_load_dwordx4 v32, s[16:19], s46 offen lds
    s_add_u32 m0, s44, 5120
    s_add_u32 s46, s54, 8192
    buffer_load_dwordx4 v33, s[16:19], s46 offen lds
    s_waitcnt vmcnt(6)
    s_add_u32 m0, s44, 6144
    s_add_u32 s46, s54, 16384
    buffer_load_dwordx4 v32, s[16:19], s46 offen lds
    s_add_u32 m0, s44, 7168
    s_add_u32 s46, s54, 24576
    buffer_load_dwordx4 v33, s[16:19], s46 offen lds
    s_waitcnt vmcnt(6)
    s_add_u32 m0, s45, 0
    s_add_u32 s46, s55, 0
    buffer_load_dwordx4 v32, s[12:15], s46 offen lds
    s_add_u32 m0, s45, 1024
    s_add_u32 s46, s55, 8192
    buffer_load_dwordx4 v33, s[12:15], s46 offen lds
    s_waitcnt vmcnt(6)
    s_add_u32 m0, s45, 2048
    s_add_u32 s46, s55, 16384
    buffer_load_dwordx4 v32, s[12:15], s46 offen lds
    s_add_u32 m0, s45, 3072
    s_add_u32 s46, s55, 24576
    buffer_load_dwordx4 v33, s[12:15], s46 offen lds
    s_waitcnt vmcnt(6)
    s_add_u32 m0, s45, 4096
    s_add_u32 s46, s55, 0
    buffer_load_dwordx4 v32, s[16:19], s46 offen lds
    s_add_u32 m0, s45, 5120
    s_add_u32 s46, s55, 8192
    buffer_load_dwordx4 v33, s[16:19], s46 offen lds
    s_waitcnt vmcnt(6)
    s_add_u32 m0, s45, 6144
    s_add_u32 s46, s55, 16384
    buffer_load_dwordx4 v32, s[16:19], s46 offen lds
    s_add_u32 m0, s45, 7168
    s_add_u32 s46, s55, 24576
    buffer_load_dwordx4 v33, s[16:19], s46 offen lds
    s_waitcnt vmcnt(6)
    s_add_u32 m0, s47, 0
    s_add_u32 s46, s70, 0
    buffer_load_dwordx4 v32, s[12:15], s46 offen lds
    s_add_u32 m0, s47, 1024
    s_add_u32 s46, s70, 8192
    buffer_load_dwordx4 v33, s[12:15], s46 offen lds
    s_waitcnt vmcnt(6)
    s_add_u32 m0, s47, 2048
    s_add_u32 s46, s70, 16384
    buffer_load_dwordx4 v32, s[12:15], s46 offen lds
    s_add_u32 m0, s47, 3072
    s_add_u32 s46, s70, 24576
    buffer_load_dwordx4 v33, s[12:15], s46 offen lds
    s_waitcnt vmcnt(6)
    s_add_u32 m0, s47, 4096
    s_add_u32 s46, s70, 0
    buffer_load_dwordx4 v32, s[16:19], s46 offen lds
    s_add_u32 m0, s47, 5120
    s_add_u32 s46, s70, 8192
    buffer_load_dwordx4 v33, s[16:19], s46 offen lds
    s_waitcnt vmcnt(6)
    s_add_u32 m0, s47, 6144
    s_add_u32 s46, s70, 16384
    buffer_load_dwordx4 v32, s[16:19], s46 offen lds
    s_add_u32 m0, s47, 7168
    s_add_u32 s46, s70, 24576
    buffer_load_dwordx4 v33, s[16:19], s46 offen lds
    s_waitcnt vmcnt(6)
    s_add_u32 m0, s49, 0
    s_add_u32 s46, s71, 0
    buffer_load_dwordx4 v32, s[12:15], s46 offen lds
    s_add_u32 m0, s49, 1024
    s_add_u32 s46, s71, 8192
    buffer_load_dwordx4 v33, s[12:15], s46 offen lds
    s_waitcnt vmcnt(6)
    s_add_u32 m0, s49, 2048
    s_add_u32 s46, s71, 16384
    buffer_load_dwordx4 v32, s[12:15], s46 offen lds
    s_add_u32 m0, s49, 3072
    s_add_u32 s46, s71, 24576
    buffer_load_dwordx4 v33, s[12:15], s46 offen lds
    s_waitcnt vmcnt(6)
    s_add_u32 m0, s49, 4096
    s_add_u32 s46, s71, 0
    buffer_load_dwordx4 v32, s[16:19], s46 offen lds
    s_add_u32 m0, s49, 5120
    s_add_u32 s46, s71, 8192
    buffer_load_dwordx4 v33, s[16:19], s46 offen lds
    s_waitcnt vmcnt(6)
    s_add_u32 m0, s49, 6144
    s_add_u32 s46, s71, 16384
    buffer_load_dwordx4 v32, s[16:19], s46 offen lds
    s_add_u32 m0, s49, 7168
    s_add_u32 s46, s71, 24576
    buffer_load_dwordx4 v33, s[16:19], s46 offen lds
    s_waitcnt vmcnt(6)
    s_waitcnt vmcnt(0)
    ds_read_b128 v[128:131], v34 offset:0
    ds_read_b128 v[132:135], v34 offset:2048
    ds_read_b128 v[136:139], v34 offset:4096
    ds_read_b128 v[140:143], v34 offset:6144
    ds_read_b128 v[144:147], v35 offset:0
    ds_read_b128 v[148:151], v35 offset:2048
    ds_read_b128 v[152:155], v35 offset:4096
    ds_read_b128 v[156:159], v35 offset:6144
    ds_read_b128 v[160:163], v34 offset:8192
    ds_read_b128 v[164:167], v34 offset:10240
    ds_read_b128 v[168:171], v34 offset:12288
    ds_read_b128 v[172:175], v34 offset:14336
    ds_read_b128 v[176:179], v35 offset:8192
    ds_read_b128 v[180:183], v35 offset:10240
    ds_read_b128 v[184:187], v35 offset:12288
    ds_read_b128 v[188:191], v35 offset:14336
    ds_read_b128 v[192:195], v34 offset:16384
    ds_read_b128 v[196:199], v34 offset:18432
    ds_read_b128 v[200:203], v34 offset:20480
    ds_read_b128 v[204:207], v34 offset:22528
    ds_read_b128 v[208:211], v35 offset:16384
    ds_read_b128 v[212:215], v35 offset:18432
    ds_read_b128 v[216:219], v35 offset:20480
    ds_read_b128 v[220:223], v35 offset:22528
    ds_read_b128 v[224:227], v34 offset:24576
    ds_read_b128 v[228:231], v34 offset:26624
    ds_read_b128 v[232:235], v34 offset:28672
    ds_read_b128 v[236:239], v34 offset:30720
    ds_read_b128 v[240:243], v35 offset:24576
    ds_read_b128 v[244:247], v35 offset:26624
    ds_read_b128 v[248:251], v35 offset:28672
    ds_read_b128 v[252:255], v35 offset:30720
    v_lshlrev_b32 v13, 9, v5
    v_add_u32 v13, v13, v7
    v_lshlrev_b32 v13, 1, v13
    v_add_u32 v14, 0x8000, v13
    v_lshlrev_b32 v15, 1, v7
    global_load_dwordx2 v[96:97], v13, s[24:25] offset:0
    global_load_dwordx2 v[98:99], v13, s[24:25] offset:32
    global_load_dwordx2 v[100:101], v14, s[24:25] offset:0
    global_load_dwordx2 v[102:103], v14, s[24:25] offset:32
    global_load_dwordx2 v[104:105], v15, s[74:75] offset:0
    global_load_dwordx2 v[106:107], v15, s[74:75] offset:32
    v_lshlrev_b32 v7, 3, v2
    s_waitcnt lgkmcnt(0)
    s_add_u32 m0, s44, 0
    s_add_u32 s46, s54, 512
    buffer_load_dwordx4 v32, s[12:15], s46 offen lds
    s_add_u32 m0, s44, 1024
    s_add_u32 s46, s54, 8704
    buffer_load_dwordx4 v33, s[12:15], s46 offen lds
    s_waitcnt vmcnt(6)
    s_add_u32 m0, s44, 2048
    s_add_u32 s46, s54, 16896
    buffer_load_dwordx4 v32, s[12:15], s46 offen lds
    s_add_u32 m0, s44, 3072
    s_add_u32 s46, s54, 25088
    buffer_load_dwordx4 v33, s[12:15], s46 offen lds
    s_waitcnt vmcnt(6)
    s_add_u32 m0, s44, 4096
    s_add_u32 s46, s54, 512
    buffer_load_dwordx4 v32, s[16:19], s46 offen lds
    s_add_u32 m0, s44, 5120
    s_add_u32 s46, s54, 8704
    buffer_load_dwordx4 v33, s[16:19], s46 offen lds
    s_waitcnt vmcnt(6)
    s_add_u32 m0, s44, 6144
    s_add_u32 s46, s54, 16896
    buffer_load_dwordx4 v32, s[16:19], s46 offen lds
    s_add_u32 m0, s44, 7168
    s_add_u32 s46, s54, 25088
    buffer_load_dwordx4 v33, s[16:19], s46 offen lds
    s_waitcnt vmcnt(6)
    s_add_u32 m0, s45, 0
    s_add_u32 s46, s55, 512
    buffer_load_dwordx4 v32, s[12:15], s46 offen lds
    s_add_u32 m0, s45, 1024
    s_add_u32 s46, s55, 8704
    buffer_load_dwordx4 v33, s[12:15], s46 offen lds
    s_waitcnt vmcnt(6)
    s_add_u32 m0, s45, 2048
    s_add_u32 s46, s55, 16896
    buffer_load_dwordx4 v32, s[12:15], s46 offen lds
    s_add_u32 m0, s45, 3072
    s_add_u32 s46, s55, 25088
    buffer_load_dwordx4 v33, s[12:15], s46 offen lds
    s_waitcnt vmcnt(6)
    s_add_u32 m0, s45, 4096
    s_add_u32 s46, s55, 512
    buffer_load_dwordx4 v32, s[16:19], s46 offen lds
    s_add_u32 m0, s45, 5120
    s_add_u32 s46, s55, 8704
    buffer_load_dwordx4 v33, s[16:19], s46 offen lds
    s_waitcnt vmcnt(6)
    s_add_u32 m0, s45, 6144
    s_add_u32 s46, s55, 16896
    buffer_load_dwordx4 v32, s[16:19], s46 offen lds
    s_add_u32 m0, s45, 7168
    s_add_u32 s46, s55, 25088
    buffer_load_dwordx4 v33, s[16:19], s46 offen lds
    s_waitcnt vmcnt(6)
    s_add_u32 m0, s47, 0
    s_add_u32 s46, s70, 512
    buffer_load_dwordx4 v32, s[12:15], s46 offen lds
    s_add_u32 m0, s47, 1024
    s_add_u32 s46, s70, 8704
    buffer_load_dwordx4 v33, s[12:15], s46 offen lds
    s_waitcnt vmcnt(6)
    s_add_u32 m0, s47, 2048
    s_add_u32 s46, s70, 16896
    buffer_load_dwordx4 v32, s[12:15], s46 offen lds
    s_add_u32 m0, s47, 3072
    s_add_u32 s46, s70, 25088
    buffer_load_dwordx4 v33, s[12:15], s46 offen lds
    s_waitcnt vmcnt(6)
    s_add_u32 m0, s47, 4096
    s_add_u32 s46, s70, 512
    buffer_load_dwordx4 v32, s[16:19], s46 offen lds
    s_add_u32 m0, s47, 5120
    s_add_u32 s46, s70, 8704
    buffer_load_dwordx4 v33, s[16:19], s46 offen lds
    s_waitcnt vmcnt(6)
    s_add_u32 m0, s47, 6144
    s_add_u32 s46, s70, 16896
    buffer_load_dwordx4 v32, s[16:19], s46 offen lds
    s_add_u32 m0, s47, 7168
    s_add_u32 s46, s70, 25088
    buffer_load_dwordx4 v33, s[16:19], s46 offen lds
    s_waitcnt vmcnt(6)
    s_add_u32 m0, s49, 0
    s_add_u32 s46, s71, 512
    buffer_load_dwordx4 v32, s[12:15], s46 offen lds
    s_add_u32 m0, s49, 1024
    s_add_u32 s46, s71, 8704
    buffer_load_dwordx4 v33, s[12:15], s46 offen lds
    s_waitcnt vmcnt(6)
    s_add_u32 m0, s49, 2048
    s_add_u32 s46, s71, 16896
    buffer_load_dwordx4 v32, s[12:15], s46 offen lds
    s_add_u32 m0, s49, 3072
    s_add_u32 s46, s71, 25088
    buffer_load_dwordx4 v33, s[12:15], s46 offen lds
    s_waitcnt vmcnt(6)
    s_add_u32 m0, s49, 4096
    s_add_u32 s46, s71, 512
    buffer_load_dwordx4 v32, s[16:19], s46 offen lds
    s_add_u32 m0, s49, 5120
    s_add_u32 s46, s71, 8704
    buffer_load_dwordx4 v33, s[16:19], s46 offen lds
    s_waitcnt vmcnt(6)
    s_add_u32 m0, s49, 6144
    s_add_u32 s46, s71, 16896
    buffer_load_dwordx4 v32, s[16:19], s46 offen lds
    s_add_u32 m0, s49, 7168
    s_add_u32 s46, s71, 25088
    buffer_load_dwordx4 v33, s[16:19], s46 offen lds
    s_waitcnt vmcnt(6)
    v_lshlrev_b32 v108, 16, v104
    v_and_b32 v109, 0xffff0000, v104
    v_lshlrev_b32 v110, 16, v105
    v_and_b32 v111, 0xffff0000, v105
    v_lshlrev_b32 v16, 16, v96
    v_and_b32 v17, 0xffff0000, v96
    v_lshlrev_b32 v18, 16, v97
    v_and_b32 v19, 0xffff0000, v97
    v_mul_f32 v16, v16, v108
    v_mul_f32 v17, v17, v109
    v_mul_f32 v18, v18, v110
    v_mul_f32 v19, v19, v111
    v_cvt_pk_bf16_f32 v112, v16, v17
    v_lshlrev_b32 v16, 16, v112
    v_and_b32 v17, 0xffff0000, v112
    v_cvt_pk_bf16_f32 v112, v18, v19
    v_lshlrev_b32 v18, 16, v112
    v_and_b32 v19, 0xffff0000, v112
    v_lshlrev_b32 v24, 16, v100
    v_and_b32 v25, 0xffff0000, v100
    v_lshlrev_b32 v26, 16, v101
    v_and_b32 v27, 0xffff0000, v101
    v_mul_f32 v24, v24, v108
    v_mul_f32 v25, v25, v109
    v_mul_f32 v26, v26, v110
    v_mul_f32 v27, v27, v111
    v_cvt_pk_bf16_f32 v112, v24, v25
    v_lshlrev_b32 v24, 16, v112
    v_and_b32 v25, 0xffff0000, v112
    v_cvt_pk_bf16_f32 v112, v26, v27
    v_lshlrev_b32 v26, 16, v112
    v_and_b32 v27, 0xffff0000, v112
    v_lshlrev_b32 v108, 16, v106
    v_and_b32 v109, 0xffff0000, v106
    v_lshlrev_b32 v110, 16, v107
    v_and_b32 v111, 0xffff0000, v107
    v_lshlrev_b32 v20, 16, v98
    v_and_b32 v21, 0xffff0000, v98
    v_lshlrev_b32 v22, 16, v99
    v_and_b32 v23, 0xffff0000, v99
    v_mul_f32 v20, v20, v108
    v_mul_f32 v21, v21, v109
    v_mul_f32 v22, v22, v110
    v_mul_f32 v23, v23, v111
    v_cvt_pk_bf16_f32 v112, v20, v21
    v_lshlrev_b32 v20, 16, v112
    v_and_b32 v21, 0xffff0000, v112
    v_cvt_pk_bf16_f32 v112, v22, v23
    v_lshlrev_b32 v22, 16, v112
    v_and_b32 v23, 0xffff0000, v112
    v_lshlrev_b32 v28, 16, v102
    v_and_b32 v29, 0xffff0000, v102
    v_lshlrev_b32 v30, 16, v103
    v_and_b32 v31, 0xffff0000, v103
    v_mul_f32 v28, v28, v108
    v_mul_f32 v29, v29, v109
    v_mul_f32 v30, v30, v110
    v_mul_f32 v31, v31, v111
    v_cvt_pk_bf16_f32 v112, v28, v29
    v_lshlrev_b32 v28, 16, v112
    v_and_b32 v29, 0xffff0000, v112
    v_cvt_pk_bf16_f32 v112, v30, v31
    v_lshlrev_b32 v30, 16, v112
    v_and_b32 v31, 0xffff0000, v112
    s_waitcnt vmcnt(0)
    s_barrier
    s_mov_b32 s46, 0
    s_mov_b64 exec, 0xff
G10_FP:
    buffer_load_dwordx2 v[0:1], v7, s[20:23], s48 offen sc1
    s_waitcnt vmcnt(0)
    v_cmp_eq_u32 vcc, s26, v0
    v_cmp_eq_u32 s[52:53], s27, v1
    s_and_b64 vcc, vcc, s[52:53]
    s_cmp_eq_u64 vcc, 0xff
    s_cbranch_scc1 G10_FPD
    s_add_u32 s46, s46, 1
    s_cmp_ge_u32 s46, 0x40000
    s_cbranch_scc1 G10_FPD
    s_sleep 6
    s_branch G10_FP
G10_FPD:
    s_mov_b64 exec, -1
    s_barrier
    s_add_u32 m0, s33, 0
    s_add_u32 s46, s32, 0
    buffer_load_dwordx4 v10, s[20:23], s46 offen offset:0 sc1 lds
    buffer_load_dwordx4 v10, s[20:23], s46 offen offset:1024 sc1 lds
    s_add_u32 m0, s33, 2048
    s_add_u32 s46, s32, 2048
    buffer_load_dwordx4 v10, s[20:23], s46 offen offset:0 sc1 lds
    buffer_load_dwordx4 v10, s[20:23], s46 offen offset:1024 sc1 lds
    s_add_u32 m0, s33, 4096
    s_add_u32 s46, s32, 4096
    buffer_load_dwordx4 v10, s[20:23], s46 offen offset:0 sc1 lds
    buffer_load_dwordx4 v10, s[20:23], s46 offen offset:1024 sc1 lds
    s_add_u32 m0, s33, 6144
    s_add_u32 s46, s32, 6144
    buffer_load_dwordx4 v10, s[20:23], s46 offen offset:0 sc1 lds
    buffer_load_dwordx4 v10, s[20:23], s46 offen offset:1024 sc1 lds
    s_add_u32 m0, s33, 8192
    s_add_u32 s46, s32, 32768
    buffer_load_dwordx4 v10, s[20:23], s46 offen offset:0 sc1 lds
    buffer_load_dwordx4 v10, s[20:23], s46 offen offset:1024 sc1 lds
    s_add_u32 m0, s33, 10240
    s_add_u32 s46, s32, 34816
    buffer_load_dwordx4 v10, s[20:23], s46 offen offset:0 sc1 lds
    buffer_load_dwordx4 v10, s[20:23], s46 offen offset:1024 sc1 lds
    s_add_u32 m0, s33, 12288
    s_add_u32 s46, s32, 36864
    buffer_load_dwordx4 v10, s[20:23], s46 offen offset:0 sc1 lds
    buffer_load_dwordx4 v10, s[20:23], s46 offen offset:1024 sc1 lds
    s_add_u32 m0, s33, 14336
    s_add_u32 s46, s32, 38912
    buffer_load_dwordx4 v10, s[20:23], s46 offen offset:0 sc1 lds
    buffer_load_dwordx4 v10, s[20:23], s46 offen offset:1024 sc1 lds
    s_add_u32 m0, s33, 16384
    s_add_u32 s46, s32, 65536
    buffer_load_dwordx4 v10, s[20:23], s46 offen offset:0 sc1 lds
    buffer_load_dwordx4 v10, s[20:23], s46 offen offset:1024 sc1 lds
    s_add_u32 m0, s33, 18432
    s_add_u32 s46, s32, 67584
    buffer_load_dwordx4 v10, s[20:23], s46 offen offset:0 sc1 lds
    buffer_load_dwordx4 v10, s[20:23], s46 offen offset:1024 sc1 lds
    s_add_u32 m0, s33, 20480
    s_add_u32 s46, s32, 69632
    buffer_load_dwordx4 v10, s[20:23], s46 offen offset:0 sc1 lds
    buffer_load_dwordx4 v10, s[20:23], s46 offen offset:1024 sc1 lds
    s_add_u32 m0, s33, 22528
    s_add_u32 s46, s32, 71680
    buffer_load_dwordx4 v10, s[20:23], s46 offen offset:0 sc1 lds
    buffer_load_dwordx4 v10, s[20:23], s46 offen offset:1024 sc1 lds
    s_add_u32 m0, s33, 24576
    s_add_u32 s46, s32, 98304
    buffer_load_dwordx4 v10, s[20:23], s46 offen offset:0 sc1 lds
    buffer_load_dwordx4 v10, s[20:23], s46 offen offset:1024 sc1 lds
    s_add_u32 m0, s33, 26624
    s_add_u32 s46, s32, 100352
    buffer_load_dwordx4 v10, s[20:23], s46 offen offset:0 sc1 lds
    buffer_load_dwordx4 v10, s[20:23], s46 offen offset:1024 sc1 lds
    s_add_u32 m0, s33, 28672
    s_add_u32 s46, s32, 102400
    buffer_load_dwordx4 v10, s[20:23], s46 offen offset:0 sc1 lds
    buffer_load_dwordx4 v10, s[20:23], s46 offen offset:1024 sc1 lds
    s_add_u32 m0, s33, 30720
    s_add_u32 s46, s32, 104448
    buffer_load_dwordx4 v10, s[20:23], s46 offen offset:0 sc1 lds
    buffer_load_dwordx4 v10, s[20:23], s46 offen offset:1024 sc1 lds
    v_add_u32 v5, 0x20000, v6
    s_waitcnt vmcnt(24)
    s_barrier
    ds_read_b128 v[64:67], v8 offset:0
    ds_read_b128 v[68:71], v8 offset:512
    ds_read_b128 v[72:75], v8 offset:2048
    ds_read_b128 v[76:79], v8 offset:2560
    ds_read_b128 v[80:83], v8 offset:4096
    ds_read_b128 v[84:87], v8 offset:4608
    ds_read_b128 v[88:91], v8 offset:6144
    ds_read_b128 v[92:95], v8 offset:6656
    ds_read_b128 v[96:99], v8 offset:32768
    s_waitcnt lgkmcnt(8)
    v_mfma_f32_16x16x32_bf16 v[32:35], v[128:131], v[64:67], 0
    v_mfma_f32_16x16x32_bf16 v[36:39], v[132:135], v[64:67], 0
    ds_read_b128 v[100:103], v8 offset:33280
    s_waitcnt lgkmcnt(8)
    v_mfma_f32_16x16x32_bf16 v[32:35], v[136:139], v[68:71], v[32:35]
    v_mfma_f32_16x16x32_bf16 v[36:39], v[140:143], v[68:71], v[36:39]
    ds_read_b128 v[104:107], v8 offset:34816
    s_waitcnt lgkmcnt(8)
    v_mfma_f32_16x16x32_bf16 v[32:35], v[144:147], v[72:75], v[32:35]
    v_mfma_f32_16x16x32_bf16 v[36:39], v[148:151], v[72:75], v[36:39]
    ds_read_b128 v[108:111], v8 offset:35328
    s_waitcnt lgkmcnt(8)
    v_mfma_f32_16x16x32_bf16 v[32:35], v[152:155], v[76:79], v[32:35]
    v_mfma_f32_16x16x32_bf16 v[36:39], v[156:159], v[76:79], v[36:39]
    ds_read_b128 v[64:67], v8 offset:36864
    s_waitcnt lgkmcnt(8)
    v_mfma_f32_16x16x32_bf16 v[32:35], v[160:163], v[80:83], v[32:35]
    v_mfma_f32_16x16x32_bf16 v[36:39], v[164:167], v[80:83], v[36:39]
    ds_read_b128 v[68:71], v8 offset:37376
    s_waitcnt lgkmcnt(8)
    v_mfma_f32_16x16x32_bf16 v[32:35], v[168:171], v[84:87], v[32:35]
    v_mfma_f32_16x16x32_bf16 v[36:39], v[172:175], v[84:87], v[36:39]
    ds_read_b128 v[72:75], v8 offset:38912
    s_waitcnt lgkmcnt(8)
    v_mfma_f32_16x16x32_bf16 v[32:35], v[176:179], v[88:91], v[32:35]
    v_mfma_f32_16x16x32_bf16 v[36:39], v[180:183], v[88:91], v[36:39]
    ds_read_b128 v[76:79], v8 offset:39424
    s_waitcnt lgkmcnt(8)
    v_mfma_f32_16x16x32_bf16 v[32:35], v[184:187], v[92:95], v[32:35]
    v_mfma_f32_16x16x32_bf16 v[36:39], v[188:191], v[92:95], v[36:39]
    s_waitcnt vmcnt(16)
    s_barrier
    ds_read_b128 v[80:83], v8 offset:8192
    s_waitcnt lgkmcnt(8)
    v_mfma_f32_16x16x32_bf16 v[32:35], v[192:195], v[96:99], v[32:35]
    v_mfma_f32_16x16x32_bf16 v[36:39], v[196:199], v[96:99], v[36:39]
    ds_read_b128 v[84:87], v8 offset:8704
    s_waitcnt lgkmcnt(8)
    v_mfma_f32_16x16x32_bf16 v[32:35], v[200:203], v[100:103], v[32:35]
    v_mfma_f32_16x16x32_bf16 v[36:39], v[204:207], v[100:103], v[36:39]
    ds_read_b128 v[88:91], v8 offset:10240
    s_waitcnt lgkmcnt(8)
    v_mfma_f32_16x16x32_bf16 v[32:35], v[208:211], v[104:107], v[32:35]
    v_mfma_f32_16x16x32_bf16 v[36:39], v[212:215], v[104:107], v[36:39]
    ds_read_b128 v[92:95], v8 offset:10752
    s_waitcnt lgkmcnt(8)
    v_mfma_f32_16x16x32_bf16 v[32:35], v[216:219], v[108:111], v[32:35]
    v_mfma_f32_16x16x32_bf16 v[36:39], v[220:223], v[108:111], v[36:39]
    ds_read_b128 v[96:99], v8 offset:12288
    s_waitcnt lgkmcnt(8)
    v_mfma_f32_16x16x32_bf16 v[32:35], v[224:227], v[64:67], v[32:35]
    v_mfma_f32_16x16x32_bf16 v[36:39], v[228:231], v[64:67], v[36:39]
    ds_read_b128 v[100:103], v8 offset:12800
    s_waitcnt lgkmcnt(8)
    v_mfma_f32_16x16x32_bf16 v[32:35], v[232:235], v[68:71], v[32:35]
    v_mfma_f32_16x16x32_bf16 v[36:39], v[236:239], v[68:71], v[36:39]
    ds_read_b128 v[104:107], v8 offset:14336
    s_waitcnt lgkmcnt(8)
    v_mfma_f32_16x16x32_bf16 v[32:35], v[240:243], v[72:75], v[32:35]
    v_mfma_f32_16x16x32_bf16 v[36:39], v[244:247], v[72:75], v[36:39]
    ds_read_b128 v[108:111], v8 offset:14848
    s_waitcnt lgkmcnt(8)
    v_mfma_f32_16x16x32_bf16 v[32:35], v[248:251], v[76:79], v[32:35]
    v_mfma_f32_16x16x32_bf16 v[36:39], v[252:255], v[76:79], v[36:39]
    ds_read_b128 v[64:67], v8 offset:40960
    s_waitcnt lgkmcnt(8)
    v_mfma_f32_16x16x32_bf16 v[40:43], v[128:131], v[80:83], 0
    v_mfma_f32_16x16x32_bf16 v[44:47], v[132:135], v[80:83], 0
    ds_read_b128 v[68:71], v8 offset:41472
    s_waitcnt lgkmcnt(8)
    v_mfma_f32_16x16x32_bf16 v[40:43], v[136:139], v[84:87], v[40:43]
    v_mfma_f32_16x16x32_bf16 v[44:47], v[140:143], v[84:87], v[44:47]
    ds_read_b128 v[72:75], v8 offset:43008
    s_waitcnt lgkmcnt(8)
    v_mfma_f32_16x16x32_bf16 v[40:43], v[144:147], v[88:91], v[40:43]
    v_mfma_f32_16x16x32_bf16 v[44:47], v[148:151], v[88:91], v[44:47]
    ds_read_b128 v[76:79], v8 offset:43520
    s_waitcnt lgkmcnt(8)
    v_mfma_f32_16x16x32_bf16 v[40:43], v[152:155], v[92:95], v[40:43]
    v_mfma_f32_16x16x32_bf16 v[44:47], v[156:159], v[92:95], v[44:47]
    ds_read_b128 v[80:83], v8 offset:45056
    s_waitcnt lgkmcnt(8)
    v_mfma_f32_16x16x32_bf16 v[40:43], v[160:163], v[96:99], v[40:43]
    v_mfma_f32_16x16x32_bf16 v[44:47], v[164:167], v[96:99], v[44:47]
    ds_read_b128 v[84:87], v8 offset:45568
    s_waitcnt lgkmcnt(8)
    v_mfma_f32_16x16x32_bf16 v[40:43], v[168:171], v[100:103], v[40:43]
    v_mfma_f32_16x16x32_bf16 v[44:47], v[172:175], v[100:103], v[44:47]
    ds_read_b128 v[88:91], v8 offset:47104
    s_waitcnt lgkmcnt(8)
    v_mfma_f32_16x16x32_bf16 v[40:43], v[176:179], v[104:107], v[40:43]
    v_mfma_f32_16x16x32_bf16 v[44:47], v[180:183], v[104:107], v[44:47]
    ds_read_b128 v[92:95], v8 offset:47616
    s_waitcnt lgkmcnt(8)
    v_mfma_f32_16x16x32_bf16 v[40:43], v[184:187], v[108:111], v[40:43]
    v_mfma_f32_16x16x32_bf16 v[44:47], v[188:191], v[108:111], v[44:47]
    s_waitcnt vmcnt(8)
    s_barrier
    s_setprio 2
    ds_read_b128 v[112:115], v12 offset:0
    ds_read_b128 v[116:119], v12 offset:1024
    ds_read_b128 v[96:99], v8 offset:16384
    s_waitcnt lgkmcnt(10)
    v_mfma_f32_16x16x32_bf16 v[40:43], v[192:195], v[64:67], v[40:43]
    v_mfma_f32_16x16x32_bf16 v[44:47], v[196:199], v[64:67], v[44:47]
    ds_read_b128 v[100:103], v8 offset:16896
    s_waitcnt lgkmcnt(10)
    v_mfma_f32_16x16x32_bf16 v[40:43], v[200:203], v[68:71], v[40:43]
    v_mfma_f32_16x16x32_bf16 v[44:47], v[204:207], v[68:71], v[44:47]
    ds_read_b128 v[104:107], v8 offset:18432
    s_waitcnt lgkmcnt(10)
    v_mfma_f32_16x16x32_bf16 v[40:43], v[208:211], v[72:75], v[40:43]
    v_mfma_f32_16x16x32_bf16 v[44:47], v[212:215], v[72:75], v[44:47]
    s_waitcnt lgkmcnt(4)
    v_add_f32 v112, v112, v32
    v_add_f32 v113, v113, v33
    v_add_f32 v114, v114, v34
    v_add_f32 v115, v115, v35
    v_fma_f32 v112, 2.0, v112, v16
    v_fma_f32 v113, 2.0, v113, v17
    v_fma_f32 v114, 2.0, v114, v18
    v_fma_f32 v115, 2.0, v115, v19
    buffer_store_dwordx4 v[112:115], v6, s[36:39], 0 offen offset:0 sc1
    s_waitcnt lgkmcnt(3)
    v_add_f32 v116, v116, v36
    v_add_f32 v117, v117, v37
    v_add_f32 v118, v118, v38
    v_add_f32 v119, v119, v39
    v_fma_f32 v116, 2.0, v116, v20
    v_fma_f32 v117, 2.0, v117, v21
    v_fma_f32 v118, 2.0, v118, v22
    v_fma_f32 v119, 2.0, v119, v23
    buffer_store_dwordx4 v[116:119], v6, s[36:39], 0 offen offset:64 sc1
    ds_read_b128 v[108:111], v8 offset:18944
    s_waitcnt lgkmcnt(10)
    v_mfma_f32_16x16x32_bf16 v[40:43], v[216:219], v[76:79], v[40:43]
    v_mfma_f32_16x16x32_bf16 v[44:47], v[220:223], v[76:79], v[44:47]
    ds_read_b128 v[64:67], v8 offset:20480
    s_waitcnt lgkmcnt(10)
    v_mfma_f32_16x16x32_bf16 v[40:43], v[224:227], v[80:83], v[40:43]
    v_mfma_f32_16x16x32_bf16 v[44:47], v[228:231], v[80:83], v[44:47]
    ds_read_b128 v[68:71], v8 offset:20992
    s_waitcnt lgkmcnt(10)
    v_mfma_f32_16x16x32_bf16 v[40:43], v[232:235], v[84:87], v[40:43]
    v_mfma_f32_16x16x32_bf16 v[44:47], v[236:239], v[84:87], v[44:47]
    ds_read_b128 v[72:75], v8 offset:22528
    s_waitcnt lgkmcnt(10)
    v_mfma_f32_16x16x32_bf16 v[40:43], v[240:243], v[88:91], v[40:43]
    v_mfma_f32_16x16x32_bf16 v[44:47], v[244:247], v[88:91], v[44:47]
    ds_read_b128 v[76:79], v8 offset:23040
    s_waitcnt lgkmcnt(10)
    v_mfma_f32_16x16x32_bf16 v[40:43], v[248:251], v[92:95], v[40:43]
    v_mfma_f32_16x16x32_bf16 v[44:47], v[252:255], v[92:95], v[44:47]
    s_nop 9
    ds_write_b128 v11, v[40:43] offset:0
    ds_write_b128 v11, v[44:47] offset:1024
    ds_read_b128 v[80:83], v8 offset:49152
    s_waitcnt lgkmcnt(10)
    v_mfma_f32_16x16x32_bf16 v[32:35], v[128:131], v[96:99], 0
    v_mfma_f32_16x16x32_bf16 v[36:39], v[132:135], v[96:99], 0
    ds_read_b128 v[84:87], v8 offset:49664
    s_waitcnt lgkmcnt(10)
    v_mfma_f32_16x16x32_bf16 v[32:35], v[136:139], v[100:103], v[32:35]
    v_mfma_f32_16x16x32_bf16 v[36:39], v[140:143], v[100:103], v[36:39]
    ds_read_b128 v[88:91], v8 offset:51200
    s_waitcnt lgkmcnt(10)
    v_mfma_f32_16x16x32_bf16 v[32:35], v[144:147], v[104:107], v[32:35]
    v_mfma_f32_16x16x32_bf16 v[36:39], v[148:151], v[104:107], v[36:39]
    ds_read_b128 v[92:95], v8 offset:51712
    s_waitcnt lgkmcnt(10)
    v_mfma_f32_16x16x32_bf16 v[32:35], v[152:155], v[108:111], v[32:35]
    v_mfma_f32_16x16x32_bf16 v[36:39], v[156:159], v[108:111], v[36:39]
    ds_read_b128 v[96:99], v8 offset:53248
    s_waitcnt lgkmcnt(10)
    v_mfma_f32_16x16x32_bf16 v[32:35], v[160:163], v[64:67], v[32:35]
    v_mfma_f32_16x16x32_bf16 v[36:39], v[164:167], v[64:67], v[36:39]
    ds_read_b128 v[100:103], v8 offset:53760
    s_waitcnt lgkmcnt(10)
    v_mfma_f32_16x16x32_bf16 v[32:35], v[168:171], v[68:71], v[32:35]
    v_mfma_f32_16x16x32_bf16 v[36:39], v[172:175], v[68:71], v[36:39]
    ds_read_b128 v[104:107], v8 offset:55296
    s_waitcnt lgkmcnt(10)
    v_mfma_f32_16x16x32_bf16 v[32:35], v[176:179], v[72:75], v[32:35]
    v_mfma_f32_16x16x32_bf16 v[36:39], v[180:183], v[72:75], v[36:39]
    ds_read_b128 v[108:111], v8 offset:55808
    s_waitcnt lgkmcnt(10)
    v_mfma_f32_16x16x32_bf16 v[32:35], v[184:187], v[76:79], v[32:35]
    v_mfma_f32_16x16x32_bf16 v[36:39], v[188:191], v[76:79], v[36:39]
    s_waitcnt lgkmcnt(8)
    s_waitcnt vmcnt(2)
    s_barrier
    s_setprio 0
    ds_read_b128 v[64:67], v8 offset:24576
    s_waitcnt lgkmcnt(8)
    v_mfma_f32_16x16x32_bf16 v[32:35], v[192:195], v[80:83], v[32:35]
    v_mfma_f32_16x16x32_bf16 v[36:39], v[196:199], v[80:83], v[36:39]
    ds_read_b128 v[68:71], v8 offset:25088
    s_waitcnt lgkmcnt(8)
    v_mfma_f32_16x16x32_bf16 v[32:35], v[200:203], v[84:87], v[32:35]
    v_mfma_f32_16x16x32_bf16 v[36:39], v[204:207], v[84:87], v[36:39]
    ds_read_b128 v[72:75], v8 offset:26624
    s_waitcnt lgkmcnt(8)
    v_mfma_f32_16x16x32_bf16 v[32:35], v[208:211], v[88:91], v[32:35]
    v_mfma_f32_16x16x32_bf16 v[36:39], v[212:215], v[88:91], v[36:39]
    ds_read_b128 v[76:79], v8 offset:27136
    s_waitcnt lgkmcnt(8)
    v_mfma_f32_16x16x32_bf16 v[32:35], v[216:219], v[92:95], v[32:35]
    v_mfma_f32_16x16x32_bf16 v[36:39], v[220:223], v[92:95], v[36:39]
    ds_read_b128 v[80:83], v8 offset:28672
    s_waitcnt lgkmcnt(8)
    v_mfma_f32_16x16x32_bf16 v[32:35], v[224:227], v[96:99], v[32:35]
    v_mfma_f32_16x16x32_bf16 v[36:39], v[228:231], v[96:99], v[36:39]
    ds_read_b128 v[84:87], v8 offset:29184
    s_waitcnt lgkmcnt(8)
    v_mfma_f32_16x16x32_bf16 v[32:35], v[232:235], v[100:103], v[32:35]
    v_mfma_f32_16x16x32_bf16 v[36:39], v[236:239], v[100:103], v[36:39]
    ds_read_b128 v[88:91], v8 offset:30720
    s_waitcnt lgkmcnt(8)
    v_mfma_f32_16x16x32_bf16 v[32:35], v[240:243], v[104:107], v[32:35]
    v_mfma_f32_16x16x32_bf16 v[36:39], v[244:247], v[104:107], v[36:39]
    ds_read_b128 v[92:95], v8 offset:31232
    s_waitcnt lgkmcnt(8)
    v_mfma_f32_16x16x32_bf16 v[32:35], v[248:251], v[108:111], v[32:35]
    v_mfma_f32_16x16x32_bf16 v[36:39], v[252:255], v[108:111], v[36:39]
    ds_read_b128 v[96:99], v8 offset:57344
    s_waitcnt lgkmcnt(8)
    v_mfma_f32_16x16x32_bf16 v[40:43], v[128:131], v[64:67], 0
    v_mfma_f32_16x16x32_bf16 v[44:47], v[132:135], v[64:67], 0
    s_barrier
    s_setprio 3
    ds_read_b128 v[112:115], v12 offset:2048
    ds_read_b128 v[116:119], v12 offset:3072
    ds_read_b128 v[100:103], v8 offset:57856
    s_waitcnt lgkmcnt(10)
    v_mfma_f32_16x16x32_bf16 v[40:43], v[136:139], v[68:71], v[40:43]
    v_mfma_f32_16x16x32_bf16 v[44:47], v[140:143], v[68:71], v[44:47]
    ds_read_b128 v[104:107], v8 offset:59392
    s_waitcnt lgkmcnt(10)
    v_mfma_f32_16x16x32_bf16 v[40:43], v[144:147], v[72:75], v[40:43]
    v_mfma_f32_16x16x32_bf16 v[44:47], v[148:151], v[72:75], v[44:47]
    ds_read_b128 v[108:111], v8 offset:59904
    s_waitcnt lgkmcnt(10)
    v_mfma_f32_16x16x32_bf16 v[40:43], v[152:155], v[76:79], v[40:43]
    v_mfma_f32_16x16x32_bf16 v[44:47], v[156:159], v[76:79], v[44:47]
    ds_read_b128 v[64:67], v8 offset:61440
    s_waitcnt lgkmcnt(10)
    v_mfma_f32_16x16x32_bf16 v[40:43], v[160:163], v[80:83], v[40:43]
    v_mfma_f32_16x16x32_bf16 v[44:47], v[164:167], v[80:83], v[44:47]
    s_waitcnt lgkmcnt(5)
    v_add_f32 v112, v112, v32
    v_add_f32 v113, v113, v33
    v_add_f32 v114, v114, v34
    v_add_f32 v115, v115, v35
    v_fma_f32 v112, 2.0, v112, v24
    v_fma_f32 v113, 2.0, v113, v25
    v_fma_f32 v114, 2.0, v114, v26
    v_fma_f32 v115, 2.0, v115, v27
    buffer_store_dwordx4 v[112:115], v5, s[36:39], 0 offen offset:0 sc1
    s_waitcnt lgkmcnt(4)
    v_add_f32 v116, v116, v36
    v_add_f32 v117, v117, v37
    v_add_f32 v118, v118, v38
    v_add_f32 v119, v119, v39
    v_fma_f32 v116, 2.0, v116, v28
    v_fma_f32 v117, 2.0, v117, v29
    v_fma_f32 v118, 2.0, v118, v30
    v_fma_f32 v119, 2.0, v119, v31
    buffer_store_dwordx4 v[116:119], v5, s[36:39], 0 offen offset:64 sc1
    ds_read_b128 v[68:71], v8 offset:61952
    s_waitcnt lgkmcnt(10)
    v_mfma_f32_16x16x32_bf16 v[40:43], v[168:171], v[84:87], v[40:43]
    v_mfma_f32_16x16x32_bf16 v[44:47], v[172:175], v[84:87], v[44:47]
    ds_read_b128 v[72:75], v8 offset:63488
    s_waitcnt lgkmcnt(10)
    v_mfma_f32_16x16x32_bf16 v[40:43], v[176:179], v[88:91], v[40:43]
    v_mfma_f32_16x16x32_bf16 v[44:47], v[180:183], v[88:91], v[44:47]
    ds_read_b128 v[76:79], v8 offset:64000
    s_waitcnt lgkmcnt(10)
    v_mfma_f32_16x16x32_bf16 v[40:43], v[184:187], v[92:95], v[40:43]
    v_mfma_f32_16x16x32_bf16 v[44:47], v[188:191], v[92:95], v[44:47]
    s_waitcnt lgkmcnt(9)
    v_mfma_f32_16x16x32_bf16 v[40:43], v[192:195], v[96:99], v[40:43]
    v_mfma_f32_16x16x32_bf16 v[44:47], v[196:199], v[96:99], v[44:47]
    s_waitcnt lgkmcnt(6)
    v_mfma_f32_16x16x32_bf16 v[40:43], v[200:203], v[100:103], v[40:43]
    v_mfma_f32_16x16x32_bf16 v[44:47], v[204:207], v[100:103], v[44:47]
    s_waitcnt lgkmcnt(5)
    v_mfma_f32_16x16x32_bf16 v[40:43], v[208:211], v[104:107], v[40:43]
    v_mfma_f32_16x16x32_bf16 v[44:47], v[212:215], v[104:107], v[44:47]
    s_waitcnt lgkmcnt(4)
    v_mfma_f32_16x16x32_bf16 v[40:43], v[216:219], v[108:111], v[40:43]
    v_mfma_f32_16x16x32_bf16 v[44:47], v[220:223], v[108:111], v[44:47]
    s_waitcnt lgkmcnt(3)
    v_mfma_f32_16x16x32_bf16 v[40:43], v[224:227], v[64:67], v[40:43]
    v_mfma_f32_16x16x32_bf16 v[44:47], v[228:231], v[64:67], v[44:47]
    s_waitcnt lgkmcnt(2)
    v_mfma_f32_16x16x32_bf16 v[40:43], v[232:235], v[68:71], v[40:43]
    v_mfma_f32_16x16x32_bf16 v[44:47], v[236:239], v[68:71], v[44:47]
    s_waitcnt lgkmcnt(1)
    v_mfma_f32_16x16x32_bf16 v[40:43], v[240:243], v[72:75], v[40:43]
    v_mfma_f32_16x16x32_bf16 v[44:47], v[244:247], v[72:75], v[44:47]
    s_waitcnt lgkmcnt(0)
    v_mfma_f32_16x16x32_bf16 v[40:43], v[248:251], v[76:79], v[40:43]
    v_mfma_f32_16x16x32_bf16 v[44:47], v[252:255], v[76:79], v[44:47]
    s_nop 9
    ds_write_b128 v11, v[40:43] offset:2048
    ds_write_b128 v11, v[44:47] offset:3072
    s_waitcnt lgkmcnt(0)
    s_barrier
    s_lshl_b32 s42, s29, 3
    s_or_b32 s42, s42, s3
    s_lshl_b32 s42, s42, 5
    s_or_b32 s42, s42, s28
    s_cmp_lg_u32 s42, 159
    s_cbranch_scc1 G10A_NOBUMP
    v_mov_b32 v0, s26
    v_mov_b32 v1, 0
    s_mov_b32 s46, 0x20000
    s_mov_b64 exec, 1
    buffer_store_dword v0, v1, s[20:23], s46 offen sc1
    s_mov_b64 exec, -1
G10A_NOBUMP:
K1_END0:
    s_endpgm
K1_B_LOAD:
    s_lshr_b32 s49, s7, 3
    s_add_u32 s49, s49, s7
    s_mov_b32 s41, s7
    s_sub_u32 s7, s3, 4
    v_lshrrev_b32 v3, 3, v2
    v_and_b32 v4, 7, v2
    v_lshrrev_b32 v5, 4, v2
    s_lshl_b32 s42, s4, 7
    s_lshl_b32 s43, s7, 5
    s_add_u32 s42, s42, s43
    v_add_u32 v7, s42, v3
    v_lshlrev_b32 v7, 10, v7
    v_xor_b32 v6, v4, v5
    v_lshl_add_u32 v8, v6, 4, v7
    v_xor_b32 v6, 4, v6
    v_lshl_add_u32 v9, v6, 4, v7
    v_and_b32 v6, 15, v2
    v_lshrrev_b32 v6, 1, v6
    v_xor_b32 v6, v6, v5
    s_lshl_b32 s42, s7, 4
    v_add_u32 v7, s42, v5
    v_mul_u32_u24 v7, 3072, v7
    s_lshl_b32 s42, s5, 7
    s_add_u32 s42, s42, 1024
    v_add_u32 v7, s42, v7
    v_and_b32 v12, 1, v2
    v_lshl_add_u32 v7, v12, 4, v7
    v_lshrrev_b32 v12, 2, v6
    v_and_b32 v13, 3, v6
    v_lshl_add_u32 v14, v12, 10, v7
    v_lshl_add_u32 v10, v13, 5, v14
    v_xor_b32 v6, 4, v6
    v_lshrrev_b32 v12, 2, v6
    v_and_b32 v13, 3, v6
    v_lshl_add_u32 v14, v12, 10, v7
    v_lshl_add_u32 v11, v13, 5, v14
    v_lshrrev_b32 v6, 1, v4
    v_and_b32 v12, 1, v5
    v_xor_b32 v6, v6, v12
    s_lshl_b32 s42, s7, 4
    v_add_u32 v7, s42, v3
    v_mul_u32_u24 v7, 3072, v7
    s_lshl_b32 s42, s5, 7
    v_add_u32 v7, s42, v7
    v_and_b32 v12, 1, v2
    v_lshl_add_u32 v7, v12, 4, v7
    v_lshl_add_u32 v12, v6, 5, v7
    v_xor_b32 v6, 2, v6
    v_lshl_add_u32 v13, v6, 5, v7
    s_lshl_b32 s44, s7, 12
    s_add_u32 s45, s44, 16384
    s_lshl_b32 s48, s7, 11
    s_add_u32 s48, s48, 32768
    s_load_dwordx4 s[64:67], s[0:1], 40
    s_load_dwordx2 s[68:69], s[0:1], 88
    s_load_dwordx2 s[74:75], s[0:1], 64
    s_load_dwordx2 s[76:77], s[0:1], 96
    s_add_u32 s47, s49, 0
    s_and_b32 s47, s47, 7
    s_lshl_b32 s42, s47, 7
    s_mul_i32 s43, s47, 196608
    s_add_u32 m0, s44, 0
    s_add_u32 s46, s42, 0
    buffer_load_dwordx4 v8, s[8:11], s46 offen lds
    s_add_u32 m0, s44, 1024
    s_add_u32 s46, s42, 8192
    buffer_load_dwordx4 v9, s[8:11], s46 offen lds
    s_add_u32 m0, s44, 2048
    s_add_u32 s46, s42, 16384
    buffer_load_dwordx4 v8, s[8:11], s46 offen lds
    s_add_u32 m0, s44, 3072
    s_add_u32 s46, s42, 24576
    buffer_load_dwordx4 v9, s[8:11], s46 offen lds
    s_add_u32 m0, s45, 0
    s_add_u32 s46, s43, 0
    buffer_load_dwordx4 v10, s[12:15], s46 offen lds
    s_add_u32 m0, s45, 1024
    s_add_u32 s46, s43, 12288
    buffer_load_dwordx4 v10, s[12:15], s46 offen lds
    s_add_u32 m0, s45, 2048
    s_add_u32 s46, s43, 24576
    buffer_load_dwordx4 v11, s[12:15], s46 offen lds
    s_add_u32 m0, s45, 3072
    s_add_u32 s46, s43, 36864
    buffer_load_dwordx4 v11, s[12:15], s46 offen lds
    s_add_u32 m0, s48, 0
    s_add_u32 s46, s43, 0
    buffer_load_dwordx4 v12, s[12:15], s46 offen lds
    s_add_u32 m0, s48, 1024
    s_add_u32 s46, s43, 24576
    buffer_load_dwordx4 v13, s[12:15], s46 offen lds
    s_waitcnt vmcnt(0)
    s_barrier
    s_add_u32 s47, s49, 1
    s_and_b32 s47, s47, 7
    s_lshl_b32 s42, s47, 7
    s_mul_i32 s43, s47, 196608
    s_add_u32 m0, s44, 40960
    s_add_u32 s46, s42, 0
    buffer_load_dwordx4 v8, s[8:11], s46 offen lds
    s_add_u32 m0, s44, 41984
    s_add_u32 s46, s42, 8192
    buffer_load_dwordx4 v9, s[8:11], s46 offen lds
    s_add_u32 m0, s44, 43008
    s_add_u32 s46, s42, 16384
    buffer_load_dwordx4 v8, s[8:11], s46 offen lds
    s_add_u32 m0, s44, 44032
    s_add_u32 s46, s42, 24576
    buffer_load_dwordx4 v9, s[8:11], s46 offen lds
    s_add_u32 m0, s45, 40960
    s_add_u32 s46, s43, 0
    buffer_load_dwordx4 v10, s[12:15], s46 offen lds
    s_add_u32 m0, s45, 41984
    s_add_u32 s46, s43, 12288
    buffer_load_dwordx4 v10, s[12:15], s46 offen lds
    s_add_u32 m0, s45, 43008
    s_add_u32 s46, s43, 24576
    buffer_load_dwordx4 v11, s[12:15], s46 offen lds
    s_add_u32 m0, s45, 44032
    s_add_u32 s46, s43, 36864
    buffer_load_dwordx4 v11, s[12:15], s46 offen lds
    s_add_u32 m0, s48, 40960
    s_add_u32 s46, s43, 0
    buffer_load_dwordx4 v12, s[12:15], s46 offen lds
    s_add_u32 m0, s48, 41984
    s_add_u32 s46, s43, 24576
    buffer_load_dwordx4 v13, s[12:15], s46 offen lds
    s_add_u32 s47, s49, 2
    s_and_b32 s47, s47, 7
    s_lshl_b32 s42, s47, 7
    s_mul_i32 s43, s47, 196608
    s_add_u32 m0, s44, 81920
    s_add_u32 s46, s42, 0
    buffer_load_dwordx4 v8, s[8:11], s46 offen lds
    s_add_u32 m0, s44, 82944
    s_add_u32 s46, s42, 8192
    buffer_load_dwordx4 v9, s[8:11], s46 offen lds
    s_add_u32 m0, s44, 83968
    s_add_u32 s46, s42, 16384
    buffer_load_dwordx4 v8, s[8:11], s46 offen lds
    s_add_u32 m0, s44, 84992
    s_add_u32 s46, s42, 24576
    buffer_load_dwordx4 v9, s[8:11], s46 offen lds
    s_add_u32 m0, s45, 81920
    s_add_u32 s46, s43, 0
    buffer_load_dwordx4 v10, s[12:15], s46 offen lds
    s_add_u32 m0, s45, 82944
    s_add_u32 s46, s43, 12288
    buffer_load_dwordx4 v10, s[12:15], s46 offen lds
    s_add_u32 m0, s45, 83968
    s_add_u32 s46, s43, 24576
    buffer_load_dwordx4 v11, s[12:15], s46 offen lds
    s_add_u32 m0, s45, 84992
    s_add_u32 s46, s43, 36864
    buffer_load_dwordx4 v11, s[12:15], s46 offen lds
    s_add_u32 m0, s48, 81920
    s_add_u32 s46, s43, 0
    buffer_load_dwordx4 v12, s[12:15], s46 offen lds
    s_add_u32 m0, s48, 82944
    s_add_u32 s46, s43, 24576
    buffer_load_dwordx4 v13, s[12:15], s46 offen lds
    s_waitcnt vmcnt(10)
    s_barrier
    s_add_u32 s47, s49, 3
    s_and_b32 s47, s47, 7
    s_lshl_b32 s42, s47, 7
    s_mul_i32 s43, s47, 196608
    s_add_u32 m0, s44, 122880
    s_add_u32 s46, s42, 0
    buffer_load_dwordx4 v8, s[8:11], s46 offen lds
    s_add_u32 m0, s44, 123904
    s_add_u32 s46, s42, 8192
    buffer_load_dwordx4 v9, s[8:11], s46 offen lds
    s_add_u32 m0, s44, 124928
    s_add_u32 s46, s42, 16384
    buffer_load_dwordx4 v8, s[8:11], s46 offen lds
    s_add_u32 m0, s44, 125952
    s_add_u32 s46, s42, 24576
    buffer_load_dwordx4 v9, s[8:11], s46 offen lds
    s_add_u32 m0, s45, 122880
    s_add_u32 s46, s43, 0
    buffer_load_dwordx4 v10, s[12:15], s46 offen lds
    s_add_u32 m0, s45, 123904
    s_add_u32 s46, s43, 12288
    buffer_load_dwordx4 v10, s[12:15], s46 offen lds
    s_add_u32 m0, s45, 124928
    s_add_u32 s46, s43, 24576
    buffer_load_dwordx4 v11, s[12:15], s46 offen lds
    s_add_u32 m0, s45, 125952
    s_add_u32 s46, s43, 36864
    buffer_load_dwordx4 v11, s[12:15], s46 offen lds
    s_add_u32 m0, s48, 122880
    s_add_u32 s46, s43, 0
    buffer_load_dwordx4 v12, s[12:15], s46 offen lds
    s_add_u32 m0, s48, 123904
    s_add_u32 s46, s43, 24576
    buffer_load_dwordx4 v13, s[12:15], s46 offen lds
    s_waitcnt vmcnt(10)
    s_barrier
    s_add_u32 s47, s49, 4
    s_and_b32 s47, s47, 7
    s_lshl_b32 s42, s47, 7
    s_mul_i32 s43, s47, 196608
    s_add_u32 m0, s44, 0
    s_add_u32 s46, s42, 0
    buffer_load_dwordx4 v8, s[8:11], s46 offen lds
    s_add_u32 m0, s44, 1024
    s_add_u32 s46, s42, 8192
    buffer_load_dwordx4 v9, s[8:11], s46 offen lds
    s_add_u32 m0, s44, 2048
    s_add_u32 s46, s42, 16384
    buffer_load_dwordx4 v8, s[8:11], s46 offen lds
    s_add_u32 m0, s44, 3072
    s_add_u32 s46, s42, 24576
    buffer_load_dwordx4 v9, s[8:11], s46 offen lds
    s_add_u32 m0, s45, 0
    s_add_u32 s46, s43, 0
    buffer_load_dwordx4 v10, s[12:15], s46 offen lds
    s_add_u32 m0, s45, 1024
    s_add_u32 s46, s43, 12288
    buffer_load_dwordx4 v10, s[12:15], s46 offen lds
    s_add_u32 m0, s45, 2048
    s_add_u32 s46, s43, 24576
    buffer_load_dwordx4 v11, s[12:15], s46 offen lds
    s_add_u32 m0, s45, 3072
    s_add_u32 s46, s43, 36864
    buffer_load_dwordx4 v11, s[12:15], s46 offen lds
    s_add_u32 m0, s48, 0
    s_add_u32 s46, s43, 0
    buffer_load_dwordx4 v12, s[12:15], s46 offen lds
    s_add_u32 m0, s48, 1024
    s_add_u32 s46, s43, 24576
    buffer_load_dwordx4 v13, s[12:15], s46 offen lds
    s_waitcnt vmcnt(10)
    s_barrier
    s_add_u32 s47, s49, 5
    s_and_b32 s47, s47, 7
    s_lshl_b32 s42, s47, 7
    s_mul_i32 s43, s47, 196608
    s_add_u32 m0, s44, 40960
    s_add_u32 s46, s42, 0
    buffer_load_dwordx4 v8, s[8:11], s46 offen lds
    s_add_u32 m0, s44, 41984
    s_add_u32 s46, s42, 8192
    buffer_load_dwordx4 v9, s[8:11], s46 offen lds
    s_add_u32 m0, s44, 43008
    s_add_u32 s46, s42, 16384
    buffer_load_dwordx4 v8, s[8:11], s46 offen lds
    s_add_u32 m0, s44, 44032
    s_add_u32 s46, s42, 24576
    buffer_load_dwordx4 v9, s[8:11], s46 offen lds
    s_add_u32 m0, s45, 40960
    s_add_u32 s46, s43, 0
    buffer_load_dwordx4 v10, s[12:15], s46 offen lds
    s_add_u32 m0, s45, 41984
    s_add_u32 s46, s43, 12288
    buffer_load_dwordx4 v10, s[12:15], s46 offen lds
    s_add_u32 m0, s45, 43008
    s_add_u32 s46, s43, 24576
    buffer_load_dwordx4 v11, s[12:15], s46 offen lds
    s_add_u32 m0, s45, 44032
    s_add_u32 s46, s43, 36864
    buffer_load_dwordx4 v11, s[12:15], s46 offen lds
    s_add_u32 m0, s48, 40960
    s_add_u32 s46, s43, 0
    buffer_load_dwordx4 v12, s[12:15], s46 offen lds
    s_add_u32 m0, s48, 41984
    s_add_u32 s46, s43, 24576
    buffer_load_dwordx4 v13, s[12:15], s46 offen lds
    s_waitcnt vmcnt(10)
    s_barrier
    s_add_u32 s47, s49, 6
    s_and_b32 s47, s47, 7
    s_lshl_b32 s42, s47, 7
    s_mul_i32 s43, s47, 196608
    s_add_u32 m0, s44, 81920
    s_add_u32 s46, s42, 0
    buffer_load_dwordx4 v8, s[8:11], s46 offen lds
    s_add_u32 m0, s44, 82944
    s_add_u32 s46, s42, 8192
    buffer_load_dwordx4 v9, s[8:11], s46 offen lds
    s_add_u32 m0, s44, 83968
    s_add_u32 s46, s42, 16384
    buffer_load_dwordx4 v8, s[8:11], s46 offen lds
    s_add_u32 m0, s44, 84992
    s_add_u32 s46, s42, 24576
    buffer_load_dwordx4 v9, s[8:11], s46 offen lds
    s_add_u32 m0, s45, 81920
    s_add_u32 s46, s43, 0
    buffer_load_dwordx4 v10, s[12:15], s46 offen lds
    s_add_u32 m0, s45, 82944
    s_add_u32 s46, s43, 12288
    buffer_load_dwordx4 v10, s[12:15], s46 offen lds
    s_add_u32 m0, s45, 83968
    s_add_u32 s46, s43, 24576
    buffer_load_dwordx4 v11, s[12:15], s46 offen lds
    s_add_u32 m0, s45, 84992
    s_add_u32 s46, s43, 36864
    buffer_load_dwordx4 v11, s[12:15], s46 offen lds
    s_add_u32 m0, s48, 81920
    s_add_u32 s46, s43, 0
    buffer_load_dwordx4 v12, s[12:15], s46 offen lds
    s_add_u32 m0, s48, 82944
    s_add_u32 s46, s43, 24576
    buffer_load_dwordx4 v13, s[12:15], s46 offen lds
    s_waitcnt vmcnt(10)
    s_barrier
    s_add_u32 s47, s49, 7
    s_and_b32 s47, s47, 7
    s_lshl_b32 s42, s47, 7
    s_mul_i32 s43, s47, 196608
    s_add_u32 m0, s44, 122880
    s_add_u32 s46, s42, 0
    buffer_load_dwordx4 v8, s[8:11], s46 offen lds
    s_add_u32 m0, s44, 123904
    s_add_u32 s46, s42, 8192
    buffer_load_dwordx4 v9, s[8:11], s46 offen lds
    s_add_u32 m0, s44, 124928
    s_add_u32 s46, s42, 16384
    buffer_load_dwordx4 v8, s[8:11], s46 offen lds
    s_add_u32 m0, s44, 125952
    s_add_u32 s46, s42, 24576
    buffer_load_dwordx4 v9, s[8:11], s46 offen lds
    s_add_u32 m0, s45, 122880
    s_add_u32 s46, s43, 0
    buffer_load_dwordx4 v10, s[12:15], s46 offen lds
    s_add_u32 m0, s45, 123904
    s_add_u32 s46, s43, 12288
    buffer_load_dwordx4 v10, s[12:15], s46 offen lds
    s_add_u32 m0, s45, 124928
    s_add_u32 s46, s43, 24576
    buffer_load_dwordx4 v11, s[12:15], s46 offen lds
    s_add_u32 m0, s45, 125952
    s_add_u32 s46, s43, 36864
    buffer_load_dwordx4 v11, s[12:15], s46 offen lds
    s_add_u32 m0, s48, 122880
    s_add_u32 s46, s43, 0
    buffer_load_dwordx4 v12, s[12:15], s46 offen lds
    s_add_u32 m0, s48, 123904
    s_add_u32 s46, s43, 24576
    buffer_load_dwordx4 v13, s[12:15], s46 offen lds
    s_waitcnt lgkmcnt(0)
    s_lshl_b32 s42, s41, 2
    s_add_u32 s42, s42, s7
    s_lshl_b32 s42, s42, 12
    v_lshl_add_u32 v14, v2, 4, s42
    global_load_dwordx4 v[40:43], v14, s[68:69] offset:0
    global_load_dwordx4 v[40:43], v14, s[68:69] offset:1024
    global_load_dwordx4 v[40:43], v14, s[68:69] offset:2048
    global_load_dwordx4 v[40:43], v14, s[68:69] offset:3072
    s_waitcnt vmcnt(14)
    s_barrier
    s_waitcnt vmcnt(4)
    s_barrier
    s_waitcnt lgkmcnt(0)
    s_add_u32 s26, s40, 1
    s_xor_b32 s27, s26, 0x9e3779b9
    s_mov_b32 s31, 0
    s_and_b32 s28, s6, 3
    s_lshl_b32 s28, s28, 3
    s_and_b32 s42, s41, 7
    s_or_b32 s28, s28, s42
    s_lshr_b32 s29, s41, 3
    s_and_b32 s30, s3, 3
    s_mov_b32 s36, s76
    s_and_b32 s37, s77, 0xffff
    s_mov_b32 s38, 0x800000
    s_mov_b32 s39, 0x00020000
    s_mov_b32 s8, s68
    s_and_b32 s9, s69, 0xffff
    s_mov_b32 s10, 0x80000
    s_mov_b32 s11, 0x00020000
    v_lshrrev_b32 v3, 4, v2
    v_lshrrev_b32 v16, 3, v2
    s_lshl_b32 s42, s7, 7
    v_add_u32 v16, s42, v16
    v_lshlrev_b32 v16, 10, v16
    s_lshl_b32 s42, s29, 8
    v_add_u32 v16, s42, v16
    v_and_b32 v17, 1, v2
    v_lshl_add_u32 v16, v17, 4, v16
    v_lshrrev_b32 v17, 1, v2
    v_and_b32 v17, 3, v17
    v_xor_b32 v17, v17, v3
    v_lshl_add_u32 v20, v17, 5, v16
    s_lshl_b32 s33, s7, 14
    s_add_u32 s33, s33, 32768
    s_barrier
    s_add_u32 m0, s33, 0
    s_mov_b32 s46, 0
    buffer_load_dwordx4 v20, s[8:11], s46 offen lds
    s_add_u32 m0, s33, 65536
    s_mov_b32 s46, 128
    buffer_load_dwordx4 v20, s[8:11], s46 offen lds
    s_waitcnt vmcnt(4)
    s_add_u32 m0, s33, 1024
    s_mov_b32 s46, 8192
    buffer_load_dwordx4 v20, s[8:11], s46 offen lds
    s_add_u32 m0, s33, 66560
    s_mov_b32 s46, 8320
    buffer_load_dwordx4 v20, s[8:11], s46 offen lds
    s_waitcnt vmcnt(4)
    s_add_u32 m0, s33, 2048
    s_mov_b32 s46, 16384
    buffer_load_dwordx4 v20, s[8:11], s46 offen lds
    s_add_u32 m0, s33, 67584
    s_mov_b32 s46, 16512
    buffer_load_dwordx4 v20, s[8:11], s46 offen lds
    s_waitcnt vmcnt(4)
    s_add_u32 m0, s33, 3072
    s_mov_b32 s46, 24576
    buffer_load_dwordx4 v20, s[8:11], s46 offen lds
    s_add_u32 m0, s33, 68608
    s_mov_b32 s46, 24704
    buffer_load_dwordx4 v20, s[8:11], s46 offen lds
    s_waitcnt vmcnt(4)
    s_add_u32 m0, s33, 4096
    s_mov_b32 s46, 32768
    buffer_load_dwordx4 v20, s[8:11], s46 offen lds
    s_add_u32 m0, s33, 69632
    s_mov_b32 s46, 32896
    buffer_load_dwordx4 v20, s[8:11], s46 offen lds
    s_waitcnt vmcnt(4)
    s_add_u32 m0, s33, 5120
    s_mov_b32 s46, 40960
    buffer_load_dwordx4 v20, s[8:11], s46 offen lds
    s_add_u32 m0, s33, 70656
    s_mov_b32 s46, 41088
    buffer_load_dwordx4 v20, s[8:11], s46 offen lds
    s_waitcnt vmcnt(4)
    s_add_u32 m0, s33, 6144
    s_mov_b32 s46, 49152
    buffer_load_dwordx4 v20, s[8:11], s46 offen lds
    s_add_u32 m0, s33, 71680
    s_mov_b32 s46, 49280
    buffer_load_dwordx4 v20, s[8:11], s46 offen lds
    s_waitcnt vmcnt(4)
    s_add_u32 m0, s33, 7168
    s_mov_b32 s46, 57344
    buffer_load_dwordx4 v20, s[8:11], s46 offen lds
    s_add_u32 m0, s33, 72704
    s_mov_b32 s46, 57472
    buffer_load_dwordx4 v20, s[8:11], s46 offen lds
    s_waitcnt vmcnt(4)
    s_add_u32 m0, s33, 8192
    s_mov_b32 s46, 65536
    buffer_load_dwordx4 v20, s[8:11], s46 offen lds
    s_add_u32 m0, s33, 73728
    s_mov_b32 s46, 65664
    buffer_load_dwordx4 v20, s[8:11], s46 offen lds
    s_waitcnt vmcnt(4)
    s_add_u32 m0, s33, 9216
    s_mov_b32 s46, 73728
    buffer_load_dwordx4 v20, s[8:11], s46 offen lds
    s_add_u32 m0, s33, 74752
    s_mov_b32 s46, 73856
    buffer_load_dwordx4 v20, s[8:11], s46 offen lds
    s_waitcnt vmcnt(4)
    s_add_u32 m0, s33, 10240
    s_mov_b32 s46, 81920
    buffer_load_dwordx4 v20, s[8:11], s46 offen lds
    s_add_u32 m0, s33, 75776
    s_mov_b32 s46, 82048
    buffer_load_dwordx4 v20, s[8:11], s46 offen lds
    s_waitcnt vmcnt(4)
    s_add_u32 m0, s33, 11264
    s_mov_b32 s46, 90112
    buffer_load_dwordx4 v20, s[8:11], s46 offen lds
    s_add_u32 m0, s33, 76800
    s_mov_b32 s46, 90240
    buffer_load_dwordx4 v20, s[8:11], s46 offen lds
    s_waitcnt vmcnt(4)
    s_add_u32 m0, s33, 12288
    s_mov_b32 s46, 98304
    buffer_load_dwordx4 v20, s[8:11], s46 offen lds
    s_add_u32 m0, s33, 77824
    s_mov_b32 s46, 98432
    buffer_load_dwordx4 v20, s[8:11], s46 offen lds
    s_waitcnt vmcnt(4)
    s_add_u32 m0, s33, 13312
    s_mov_b32 s46, 106496
    buffer_load_dwordx4 v20, s[8:11], s46 offen lds
    s_add_u32 m0, s33, 78848
    s_mov_b32 s46, 106624
    buffer_load_dwordx4 v20, s[8:11], s46 offen lds
    s_waitcnt vmcnt(4)
    s_add_u32 m0, s33, 14336
    s_mov_b32 s46, 114688
    buffer_load_dwordx4 v20, s[8:11], s46 offen lds
    s_add_u32 m0, s33, 79872
    s_mov_b32 s46, 114816
    buffer_load_dwordx4 v20, s[8:11], s46 offen lds
    s_waitcnt vmcnt(4)
    s_add_u32 m0, s33, 15360
    s_mov_b32 s46, 122880
    buffer_load_dwordx4 v20, s[8:11], s46 offen lds
    s_add_u32 m0, s33, 80896
    s_mov_b32 s46, 123008
    buffer_load_dwordx4 v20, s[8:11], s46 offen lds
    s_waitcnt vmcnt(4)
    s_branch G10B_COMMON
    s_endpgm
K1_COMP:
    s_load_dwordx2 s[74:75], s[0:1], 64
    s_load_dwordx2 s[76:77], s[0:1], 96
    s_cmp_ge_u32 s73, 1
    s_cbranch_scc1 K1_B_COMP
    v_lshrrev_b32 v3, 4, v2
    v_and_b32 v4, 15, v2
    v_lshrrev_b32 v5, 2, v4
    v_lshlrev_b32 v5, 5, v5
    v_and_b32 v6, 3, v4
    v_add_u32 v5, v5, v6
    v_lshlrev_b32 v5, 7, v5
    v_lshrrev_b32 v6, 1, v4
    v_xor_b32 v6, v3, v6
    v_lshl_add_u32 v5, v6, 4, v5
    v_xor_b32 v6, 64, v5
    v_add_u32 v8, 0x0, v5
    v_add_u32 v9, 0x0, v6
    v_add_u32 v10, 0xa000, v5
    v_add_u32 v11, 0xa000, v6
    v_add_u32 v12, 0x14000, v5
    v_add_u32 v13, 0x14000, v6
    v_add_u32 v14, 0x1e000, v5
    v_add_u32 v15, 0x1e000, v6
    s_lshl_b32 s42, s3, 5
    v_add_u32 v5, s42, v4
    v_lshlrev_b32 v5, 7, v5
    v_lshrrev_b32 v6, 1, v4
    v_xor_b32 v6, v3, v6
    v_lshl_add_u32 v5, v6, 4, v5
    v_xor_b32 v6, 64, v5
    v_add_u32 v18, 0x4000, v5
    v_add_u32 v19, 0x4000, v6
    v_add_u32 v20, 0xe000, v5
    v_add_u32 v21, 0xe000, v6
    v_add_u32 v22, 0x18000, v5
    v_add_u32 v23, 0x18000, v6
    v_add_u32 v24, 0x22000, v5
    v_add_u32 v25, 0x22000, v6
    s_lshl_b32 s42, s5, 6
    s_lshl_b32 s43, s3, 4
    s_add_u32 s42, s42, s43
    v_add_u32 v30, s42, v4
    v_lshlrev_b32 v31, 1, v30
    global_load_ushort v46, v31, s[26:27]
    global_load_ushort v47, v31, s[28:29]
    global_load_ushort v48, v31, s[34:35]
    v_lshlrev_b32 v248, 4, v2
    s_lshl_b32 s42, s7, 14
    s_lshl_b32 s43, s3, 12
    s_add_u32 s42, s42, s43
    s_lshl_b32 s43, s6, 19
    s_add_u32 s43, s43, s42
    buffer_load_dwordx4 v[252:255], v248, s[8:11], s43 offen offset:0
    buffer_load_dwordx4 v[252:255], v248, s[12:15], s42 offen offset:0
    buffer_load_dwordx4 v[252:255], v248, s[16:19], s42 offen offset:0
    buffer_load_dwordx4 v[252:255], v248, s[8:11], s43 offen offset:1024
    buffer_load_dwordx4 v[252:255], v248, s[12:15], s42 offen offset:1024
    buffer_load_dwordx4 v[252:255], v248, s[16:19], s42 offen offset:1024
    buffer_load_dwordx4 v[252:255], v248, s[8:11], s43 offen offset:2048
    buffer_load_dwordx4 v[252:255], v248, s[12:15], s42 offen offset:2048
    buffer_load_dwordx4 v[252:255], v248, s[16:19], s42 offen offset:2048
    buffer_load_dwordx4 v[252:255], v248, s[8:11], s43 offen offset:3072
    buffer_load_dwordx4 v[252:255], v248, s[12:15], s42 offen offset:3072
    buffer_load_dwordx4 v[252:255], v248, s[16:19], s42 offen offset:3072
    s_waitcnt vmcnt(12) lgkmcnt(0)
    s_add_u32 s40, s40, 1
    s_xor_b32 s41, s40, 0x9e3779b9
    v_lshlrev_b32 v46, 16, v46
    v_lshlrev_b32 v47, 16, v47
    v_lshlrev_b32 v48, 16, v48
    v_mul_f32 v50, s50, v48
    v_exp_f32 v50, v50
    s_nop 0
    v_cvt_pk_bf16_f32 v50, v50, v50
    v_and_b32 v50, 0xffff0000, v50
    v_mul_f32 v51, v50, v46
    v_mul_f32 v52, v50, v47
    v_mul_f32 v51, s50, v51
    v_exp_f32 v51, v51
    v_mul_f32 v52, 0.15915494, v52
    v_rndne_f32 v53, v52
    v_sub_f32 v52, v52, v53
    v_cos_f32 v53, v52
    v_sin_f32 v52, v52
    s_nop 0
    v_mul_f32 v32, v51, v53
    v_mul_f32 v33, v51, v52
    v_mul_f32 v50, v32, v32
    v_add_f32 v51, v32, v32
    v_fma_f32 v50, -v33, v33, v50
    v_mul_f32 v35, v51, v33
    v_mov_b32 v34, v50
    v_mul_f32 v50, v34, v34
    v_add_f32 v51, v34, v34
    v_fma_f32 v50, -v35, v35, v50
    v_mul_f32 v35, v51, v35
    v_mov_b32 v34, v50
    v_mul_f32 v50, v34, v34
    v_add_f32 v51, v34, v34
    v_fma_f32 v50, -v35, v35, v50
    v_mul_f32 v35, v51, v35
    v_mov_b32 v34, v50
    v_mul_f32 v50, v34, v34
    v_add_f32 v51, v34, v34
    v_fma_f32 v50, -v35, v35, v50
    v_mul_f32 v35, v51, v35
    v_mov_b32 v34, v50
    v_mul_f32 v50, v34, v34
    v_add_f32 v51, v34, v34
    v_fma_f32 v50, -v35, v35, v50
    v_mul_f32 v35, v51, v35
    v_mov_b32 v34, v50
    v_mul_f32 v50, v34, v34
    v_add_f32 v51, v34, v34
    v_fma_f32 v50, -v35, v35, v50
    v_mul_f32 v39, v51, v35
    v_mov_b32 v38, v50
    v_mul_f32 v50, v38, v34
    v_mul_f32 v51, v38, v35
    v_fma_f32 v50, -v39, v35, v50
    v_fma_f32 v53, v39, v34, v51
    v_mov_b32 v52, v50
    v_cmp_eq_u32 vcc, 1, v3
    v_cndmask_b32 v40, 1.0, v34, vcc
    v_cndmask_b32 v41, 0, v35, vcc
    v_cmp_eq_u32 vcc, 2, v3
    v_cndmask_b32 v40, v40, v38, vcc
    v_cndmask_b32 v41, v41, v39, vcc
    v_cmp_eq_u32 vcc, 3, v3
    v_cndmask_b32 v40, v40, v52, vcc
    v_cndmask_b32 v41, v41, v53, vcc
    v_mul_f32 v50, v38, v38
    v_add_f32 v51, v38, v38
    v_fma_f32 v50, -v39, v39, v50
    v_mul_f32 v39, v51, v39
    v_mov_b32 v38, v50
    v_mul_f32 v50, v38, v38
    v_add_f32 v51, v38, v38
    v_fma_f32 v50, -v39, v39, v50
    v_mul_f32 v53, v51, v39
    v_mov_b32 v52, v50
    v_mul_f32 v50, v52, v38
    v_mul_f32 v51, v52, v39
    v_fma_f32 v50, -v53, v39, v50
    v_fma_f32 v55, v53, v38, v51
    v_mov_b32 v54, v50
    v_mul_f32 v50, v52, v52
    v_add_f32 v51, v52, v52
    v_fma_f32 v50, -v53, v53, v50
    v_mul_f32 v29, v51, v53
    v_mov_b32 v28, v50
    v_cmp_eq_u32 vcc, 1, v3
    v_cndmask_b32 v26, 1.0, v38, vcc
    v_cndmask_b32 v27, 0, v39, vcc
    v_cmp_eq_u32 vcc, 2, v3
    v_cndmask_b32 v26, v26, v52, vcc
    v_cndmask_b32 v27, v27, v53, vcc
    v_cmp_eq_u32 vcc, 3, v3
    v_cndmask_b32 v26, v26, v54, vcc
    v_cndmask_b32 v27, v27, v55, vcc
    v_add_f32 v50, -1.0, v32
    v_mul_f32 v51, v46, v46
    v_fma_f32 v51, v47, v47, v51
    v_rcp_f32 v52, v51
    v_mul_f32 v53, v50, v46
    v_fma_f32 v53, v33, v47, v53
    v_mul_f32 v54, v33, v46
    v_fma_f32 v54, -v50, v47, v54
    v_fma_f32 v55, -v51, v52, 1.0
    v_fma_f32 v52, v55, v52, v52
    v_mul_f32 v36, v53, v52
    v_mul_f32 v37, v54, v52
    s_barrier
    ds_read_b128 v[160:163], v18 offset:0
    ds_read_b128 v[164:167], v18 offset:2048
    ds_read_b128 v[128:131], v8 offset:0
    ds_read_b128 v[132:135], v8 offset:512
    ds_read_b128 v[136:139], v8 offset:1024
    ds_read_b128 v[140:143], v8 offset:1536
    ds_read_b128 v[144:147], v8 offset:2048
    ds_read_b128 v[148:151], v8 offset:2560
    ds_read_b128 v[152:155], v8 offset:3072
    ds_read_b128 v[156:159], v8 offset:3584
    s_waitcnt lgkmcnt(0)
    v_mfma_f32_16x16x32_bf16 v[64:67], v[128:131], v[160:163], 0
    ds_read_b128 v[200:203], v19 offset:0
    v_mfma_f32_16x16x32_bf16 v[96:99], v[128:131], v[164:167], 0
    ds_read_b128 v[204:207], v19 offset:2048
    v_mfma_f32_16x16x32_bf16 v[68:71], v[132:135], v[160:163], 0
    v_mfma_f32_16x16x32_bf16 v[100:103], v[132:135], v[164:167], 0
    ds_read_b128 v[168:171], v9 offset:0
    v_mfma_f32_16x16x32_bf16 v[72:75], v[136:139], v[160:163], 0
    ds_read_b128 v[172:175], v9 offset:512
    v_mfma_f32_16x16x32_bf16 v[104:107], v[136:139], v[164:167], 0
    v_mfma_f32_16x16x32_bf16 v[76:79], v[140:143], v[160:163], 0
    ds_read_b128 v[176:179], v9 offset:1024
    v_mfma_f32_16x16x32_bf16 v[108:111], v[140:143], v[164:167], 0
    v_mfma_f32_16x16x32_bf16 v[80:83], v[144:147], v[160:163], 0
    ds_read_b128 v[180:183], v9 offset:1536
    v_mfma_f32_16x16x32_bf16 v[112:115], v[144:147], v[164:167], 0
    ds_read_b128 v[184:187], v9 offset:2048
    v_mfma_f32_16x16x32_bf16 v[84:87], v[148:151], v[160:163], 0
    v_mfma_f32_16x16x32_bf16 v[116:119], v[148:151], v[164:167], 0
    ds_read_b128 v[188:191], v9 offset:2560
    v_mfma_f32_16x16x32_bf16 v[88:91], v[152:155], v[160:163], 0
    ds_read_b128 v[192:195], v9 offset:3072
    v_mfma_f32_16x16x32_bf16 v[120:123], v[152:155], v[164:167], 0
    v_mfma_f32_16x16x32_bf16 v[92:95], v[156:159], v[160:163], 0
    ds_read_b128 v[196:199], v9 offset:3584
    v_mfma_f32_16x16x32_bf16 v[124:127], v[156:159], v[164:167], 0
    s_barrier
    s_waitcnt lgkmcnt(0)
    v_mfma_f32_16x16x32_bf16 v[64:67], v[168:171], v[200:203], v[64:67]
    ds_read_b128 v[160:163], v20 offset:0
    v_mfma_f32_16x16x32_bf16 v[96:99], v[168:171], v[204:207], v[96:99]
    ds_read_b128 v[164:167], v20 offset:2048
    v_mfma_f32_16x16x32_bf16 v[68:71], v[172:175], v[200:203], v[68:71]
    v_mfma_f32_16x16x32_bf16 v[100:103], v[172:175], v[204:207], v[100:103]
    ds_read_b128 v[128:131], v10 offset:0
    v_mfma_f32_16x16x32_bf16 v[72:75], v[176:179], v[200:203], v[72:75]
    ds_read_b128 v[132:135], v10 offset:512
    v_mfma_f32_16x16x32_bf16 v[104:107], v[176:179], v[204:207], v[104:107]
    v_mfma_f32_16x16x32_bf16 v[76:79], v[180:183], v[200:203], v[76:79]
    ds_read_b128 v[136:139], v10 offset:1024
    v_mfma_f32_16x16x32_bf16 v[108:111], v[180:183], v[204:207], v[108:111]
    v_mfma_f32_16x16x32_bf16 v[80:83], v[184:187], v[200:203], v[80:83]
    ds_read_b128 v[140:143], v10 offset:1536
    v_mfma_f32_16x16x32_bf16 v[112:115], v[184:187], v[204:207], v[112:115]
    ds_read_b128 v[144:147], v10 offset:2048
    v_mfma_f32_16x16x32_bf16 v[84:87], v[188:191], v[200:203], v[84:87]
    v_mfma_f32_16x16x32_bf16 v[116:119], v[188:191], v[204:207], v[116:119]
    ds_read_b128 v[148:151], v10 offset:2560
    v_mfma_f32_16x16x32_bf16 v[88:91], v[192:195], v[200:203], v[88:91]
    ds_read_b128 v[152:155], v10 offset:3072
    v_mfma_f32_16x16x32_bf16 v[120:123], v[192:195], v[204:207], v[120:123]
    v_mfma_f32_16x16x32_bf16 v[92:95], v[196:199], v[200:203], v[92:95]
    ds_read_b128 v[156:159], v10 offset:3584
    v_mfma_f32_16x16x32_bf16 v[124:127], v[196:199], v[204:207], v[124:127]
    s_waitcnt lgkmcnt(0)
    v_mfma_f32_16x16x32_bf16 v[64:67], v[128:131], v[160:163], v[64:67]
    ds_read_b128 v[200:203], v21 offset:0
    v_mfma_f32_16x16x32_bf16 v[96:99], v[128:131], v[164:167], v[96:99]
    ds_read_b128 v[204:207], v21 offset:2048
    v_mfma_f32_16x16x32_bf16 v[68:71], v[132:135], v[160:163], v[68:71]
    v_mfma_f32_16x16x32_bf16 v[100:103], v[132:135], v[164:167], v[100:103]
    ds_read_b128 v[168:171], v11 offset:0
    v_mfma_f32_16x16x32_bf16 v[72:75], v[136:139], v[160:163], v[72:75]
    ds_read_b128 v[172:175], v11 offset:512
    v_mfma_f32_16x16x32_bf16 v[104:107], v[136:139], v[164:167], v[104:107]
    v_mfma_f32_16x16x32_bf16 v[76:79], v[140:143], v[160:163], v[76:79]
    ds_read_b128 v[176:179], v11 offset:1024
    v_mfma_f32_16x16x32_bf16 v[108:111], v[140:143], v[164:167], v[108:111]
    v_mfma_f32_16x16x32_bf16 v[80:83], v[144:147], v[160:163], v[80:83]
    ds_read_b128 v[180:183], v11 offset:1536
    v_mfma_f32_16x16x32_bf16 v[112:115], v[144:147], v[164:167], v[112:115]
    ds_read_b128 v[184:187], v11 offset:2048
    v_mfma_f32_16x16x32_bf16 v[84:87], v[148:151], v[160:163], v[84:87]
    v_mfma_f32_16x16x32_bf16 v[116:119], v[148:151], v[164:167], v[116:119]
    ds_read_b128 v[188:191], v11 offset:2560
    v_mfma_f32_16x16x32_bf16 v[88:91], v[152:155], v[160:163], v[88:91]
    ds_read_b128 v[192:195], v11 offset:3072
    v_mfma_f32_16x16x32_bf16 v[120:123], v[152:155], v[164:167], v[120:123]
    v_mfma_f32_16x16x32_bf16 v[92:95], v[156:159], v[160:163], v[92:95]
    ds_read_b128 v[196:199], v11 offset:3584
    v_mfma_f32_16x16x32_bf16 v[124:127], v[156:159], v[164:167], v[124:127]
    s_barrier
    s_waitcnt lgkmcnt(0)
    v_mfma_f32_16x16x32_bf16 v[64:67], v[168:171], v[200:203], v[64:67]
    ds_read_b128 v[160:163], v22 offset:0
    v_mfma_f32_16x16x32_bf16 v[96:99], v[168:171], v[204:207], v[96:99]
    ds_read_b128 v[164:167], v22 offset:2048
    v_mfma_f32_16x16x32_bf16 v[68:71], v[172:175], v[200:203], v[68:71]
    v_mfma_f32_16x16x32_bf16 v[100:103], v[172:175], v[204:207], v[100:103]
    ds_read_b128 v[128:131], v12 offset:0
    v_mfma_f32_16x16x32_bf16 v[72:75], v[176:179], v[200:203], v[72:75]
    ds_read_b128 v[132:135], v12 offset:512
    v_mfma_f32_16x16x32_bf16 v[104:107], v[176:179], v[204:207], v[104:107]
    v_mfma_f32_16x16x32_bf16 v[76:79], v[180:183], v[200:203], v[76:79]
    ds_read_b128 v[136:139], v12 offset:1024
    v_mfma_f32_16x16x32_bf16 v[108:111], v[180:183], v[204:207], v[108:111]
    v_mfma_f32_16x16x32_bf16 v[80:83], v[184:187], v[200:203], v[80:83]
    ds_read_b128 v[140:143], v12 offset:1536
    v_mfma_f32_16x16x32_bf16 v[112:115], v[184:187], v[204:207], v[112:115]
    ds_read_b128 v[144:147], v12 offset:2048
    v_mfma_f32_16x16x32_bf16 v[84:87], v[188:191], v[200:203], v[84:87]
    v_mfma_f32_16x16x32_bf16 v[116:119], v[188:191], v[204:207], v[116:119]
    ds_read_b128 v[148:151], v12 offset:2560
    v_mfma_f32_16x16x32_bf16 v[88:91], v[192:195], v[200:203], v[88:91]
    ds_read_b128 v[152:155], v12 offset:3072
    v_mfma_f32_16x16x32_bf16 v[120:123], v[192:195], v[204:207], v[120:123]
    v_mfma_f32_16x16x32_bf16 v[92:95], v[196:199], v[200:203], v[92:95]
    ds_read_b128 v[156:159], v12 offset:3584
    v_mfma_f32_16x16x32_bf16 v[124:127], v[196:199], v[204:207], v[124:127]
    s_waitcnt lgkmcnt(0)
    v_mfma_f32_16x16x32_bf16 v[64:67], v[128:131], v[160:163], v[64:67]
    ds_read_b128 v[200:203], v23 offset:0
    v_mfma_f32_16x16x32_bf16 v[96:99], v[128:131], v[164:167], v[96:99]
    ds_read_b128 v[204:207], v23 offset:2048
    v_mfma_f32_16x16x32_bf16 v[68:71], v[132:135], v[160:163], v[68:71]
    v_mfma_f32_16x16x32_bf16 v[100:103], v[132:135], v[164:167], v[100:103]
    ds_read_b128 v[168:171], v13 offset:0
    v_mfma_f32_16x16x32_bf16 v[72:75], v[136:139], v[160:163], v[72:75]
    ds_read_b128 v[172:175], v13 offset:512
    v_mfma_f32_16x16x32_bf16 v[104:107], v[136:139], v[164:167], v[104:107]
    v_mfma_f32_16x16x32_bf16 v[76:79], v[140:143], v[160:163], v[76:79]
    ds_read_b128 v[176:179], v13 offset:1024
    v_mfma_f32_16x16x32_bf16 v[108:111], v[140:143], v[164:167], v[108:111]
    v_mfma_f32_16x16x32_bf16 v[80:83], v[144:147], v[160:163], v[80:83]
    ds_read_b128 v[180:183], v13 offset:1536
    v_mfma_f32_16x16x32_bf16 v[112:115], v[144:147], v[164:167], v[112:115]
    ds_read_b128 v[184:187], v13 offset:2048
    v_mfma_f32_16x16x32_bf16 v[84:87], v[148:151], v[160:163], v[84:87]
    v_mfma_f32_16x16x32_bf16 v[116:119], v[148:151], v[164:167], v[116:119]
    ds_read_b128 v[188:191], v13 offset:2560
    v_mfma_f32_16x16x32_bf16 v[88:91], v[152:155], v[160:163], v[88:91]
    ds_read_b128 v[192:195], v13 offset:3072
    v_mfma_f32_16x16x32_bf16 v[120:123], v[152:155], v[164:167], v[120:123]
    v_mfma_f32_16x16x32_bf16 v[92:95], v[156:159], v[160:163], v[92:95]
    ds_read_b128 v[196:199], v13 offset:3584
    v_mfma_f32_16x16x32_bf16 v[124:127], v[156:159], v[164:167], v[124:127]
    s_barrier
    s_waitcnt lgkmcnt(0)
    v_mfma_f32_16x16x32_bf16 v[64:67], v[168:171], v[200:203], v[64:67]
    ds_read_b128 v[160:163], v24 offset:0
    v_mfma_f32_16x16x32_bf16 v[96:99], v[168:171], v[204:207], v[96:99]
    ds_read_b128 v[164:167], v24 offset:2048
    v_mfma_f32_16x16x32_bf16 v[68:71], v[172:175], v[200:203], v[68:71]
    v_mfma_f32_16x16x32_bf16 v[100:103], v[172:175], v[204:207], v[100:103]
    ds_read_b128 v[128:131], v14 offset:0
    v_mfma_f32_16x16x32_bf16 v[72:75], v[176:179], v[200:203], v[72:75]
    ds_read_b128 v[132:135], v14 offset:512
    v_mfma_f32_16x16x32_bf16 v[104:107], v[176:179], v[204:207], v[104:107]
    v_mfma_f32_16x16x32_bf16 v[76:79], v[180:183], v[200:203], v[76:79]
    ds_read_b128 v[136:139], v14 offset:1024
    v_mfma_f32_16x16x32_bf16 v[108:111], v[180:183], v[204:207], v[108:111]
    v_mfma_f32_16x16x32_bf16 v[80:83], v[184:187], v[200:203], v[80:83]
    ds_read_b128 v[140:143], v14 offset:1536
    v_mfma_f32_16x16x32_bf16 v[112:115], v[184:187], v[204:207], v[112:115]
    ds_read_b128 v[144:147], v14 offset:2048
    v_mfma_f32_16x16x32_bf16 v[84:87], v[188:191], v[200:203], v[84:87]
    v_mfma_f32_16x16x32_bf16 v[116:119], v[188:191], v[204:207], v[116:119]
    ds_read_b128 v[148:151], v14 offset:2560
    v_mfma_f32_16x16x32_bf16 v[88:91], v[192:195], v[200:203], v[88:91]
    ds_read_b128 v[152:155], v14 offset:3072
    v_mfma_f32_16x16x32_bf16 v[120:123], v[192:195], v[204:207], v[120:123]
    v_mfma_f32_16x16x32_bf16 v[92:95], v[196:199], v[200:203], v[92:95]
    ds_read_b128 v[156:159], v14 offset:3584
    v_mfma_f32_16x16x32_bf16 v[124:127], v[196:199], v[204:207], v[124:127]
    s_waitcnt lgkmcnt(0)
    v_mfma_f32_16x16x32_bf16 v[64:67], v[128:131], v[160:163], v[64:67]
    ds_read_b128 v[200:203], v25 offset:0
    v_mfma_f32_16x16x32_bf16 v[96:99], v[128:131], v[164:167], v[96:99]
    ds_read_b128 v[204:207], v25 offset:2048
    v_mfma_f32_16x16x32_bf16 v[68:71], v[132:135], v[160:163], v[68:71]
    v_mfma_f32_16x16x32_bf16 v[100:103], v[132:135], v[164:167], v[100:103]
    ds_read_b128 v[168:171], v15 offset:0
    v_mfma_f32_16x16x32_bf16 v[72:75], v[136:139], v[160:163], v[72:75]
    ds_read_b128 v[172:175], v15 offset:512
    v_mfma_f32_16x16x32_bf16 v[104:107], v[136:139], v[164:167], v[104:107]
    v_mfma_f32_16x16x32_bf16 v[76:79], v[140:143], v[160:163], v[76:79]
    ds_read_b128 v[176:179], v15 offset:1024
    v_mfma_f32_16x16x32_bf16 v[108:111], v[140:143], v[164:167], v[108:111]
    v_mfma_f32_16x16x32_bf16 v[80:83], v[144:147], v[160:163], v[80:83]
    ds_read_b128 v[180:183], v15 offset:1536
    v_mfma_f32_16x16x32_bf16 v[112:115], v[144:147], v[164:167], v[112:115]
    ds_read_b128 v[184:187], v15 offset:2048
    v_mfma_f32_16x16x32_bf16 v[84:87], v[148:151], v[160:163], v[84:87]
    v_mfma_f32_16x16x32_bf16 v[116:119], v[148:151], v[164:167], v[116:119]
    ds_read_b128 v[188:191], v15 offset:2560
    v_mfma_f32_16x16x32_bf16 v[88:91], v[152:155], v[160:163], v[88:91]
    ds_read_b128 v[192:195], v15 offset:3072
    v_mfma_f32_16x16x32_bf16 v[120:123], v[152:155], v[164:167], v[120:123]
    v_mfma_f32_16x16x32_bf16 v[92:95], v[156:159], v[160:163], v[92:95]
    ds_read_b128 v[196:199], v15 offset:3584
    v_mfma_f32_16x16x32_bf16 v[124:127], v[156:159], v[164:167], v[124:127]
    s_barrier
    s_waitcnt lgkmcnt(0)
    v_mfma_f32_16x16x32_bf16 v[64:67], v[168:171], v[200:203], v[64:67]
    ds_read_b128 v[160:163], v18 offset:0
    v_mfma_f32_16x16x32_bf16 v[96:99], v[168:171], v[204:207], v[96:99]
    ds_read_b128 v[164:167], v18 offset:2048
    v_mfma_f32_16x16x32_bf16 v[68:71], v[172:175], v[200:203], v[68:71]
    v_mfma_f32_16x16x32_bf16 v[100:103], v[172:175], v[204:207], v[100:103]
    ds_read_b128 v[128:131], v8 offset:0
    v_mfma_f32_16x16x32_bf16 v[72:75], v[176:179], v[200:203], v[72:75]
    ds_read_b128 v[132:135], v8 offset:512
    v_mfma_f32_16x16x32_bf16 v[104:107], v[176:179], v[204:207], v[104:107]
    v_mfma_f32_16x16x32_bf16 v[76:79], v[180:183], v[200:203], v[76:79]
    ds_read_b128 v[136:139], v8 offset:1024
    v_mfma_f32_16x16x32_bf16 v[108:111], v[180:183], v[204:207], v[108:111]
    v_mfma_f32_16x16x32_bf16 v[80:83], v[184:187], v[200:203], v[80:83]
    ds_read_b128 v[140:143], v8 offset:1536
    v_mfma_f32_16x16x32_bf16 v[112:115], v[184:187], v[204:207], v[112:115]
    ds_read_b128 v[144:147], v8 offset:2048
    v_mfma_f32_16x16x32_bf16 v[84:87], v[188:191], v[200:203], v[84:87]
    v_mfma_f32_16x16x32_bf16 v[116:119], v[188:191], v[204:207], v[116:119]
    ds_read_b128 v[148:151], v8 offset:2560
    v_mfma_f32_16x16x32_bf16 v[88:91], v[192:195], v[200:203], v[88:91]
    ds_read_b128 v[152:155], v8 offset:3072
    v_mfma_f32_16x16x32_bf16 v[120:123], v[192:195], v[204:207], v[120:123]
    v_mfma_f32_16x16x32_bf16 v[92:95], v[196:199], v[200:203], v[92:95]
    ds_read_b128 v[156:159], v8 offset:3584
    v_mfma_f32_16x16x32_bf16 v[124:127], v[196:199], v[204:207], v[124:127]
    s_waitcnt lgkmcnt(0)
    v_mfma_f32_16x16x32_bf16 v[64:67], v[128:131], v[160:163], v[64:67]
    ds_read_b128 v[200:203], v19 offset:0
    v_mfma_f32_16x16x32_bf16 v[96:99], v[128:131], v[164:167], v[96:99]
    ds_read_b128 v[204:207], v19 offset:2048
    v_mfma_f32_16x16x32_bf16 v[68:71], v[132:135], v[160:163], v[68:71]
    v_mfma_f32_16x16x32_bf16 v[100:103], v[132:135], v[164:167], v[100:103]
    ds_read_b128 v[168:171], v9 offset:0
    v_mfma_f32_16x16x32_bf16 v[72:75], v[136:139], v[160:163], v[72:75]
    ds_read_b128 v[172:175], v9 offset:512
    v_mfma_f32_16x16x32_bf16 v[104:107], v[136:139], v[164:167], v[104:107]
    v_mfma_f32_16x16x32_bf16 v[76:79], v[140:143], v[160:163], v[76:79]
    ds_read_b128 v[176:179], v9 offset:1024
    v_mfma_f32_16x16x32_bf16 v[108:111], v[140:143], v[164:167], v[108:111]
    v_mfma_f32_16x16x32_bf16 v[80:83], v[144:147], v[160:163], v[80:83]
    ds_read_b128 v[180:183], v9 offset:1536
    v_mfma_f32_16x16x32_bf16 v[112:115], v[144:147], v[164:167], v[112:115]
    ds_read_b128 v[184:187], v9 offset:2048
    v_mfma_f32_16x16x32_bf16 v[84:87], v[148:151], v[160:163], v[84:87]
    v_mfma_f32_16x16x32_bf16 v[116:119], v[148:151], v[164:167], v[116:119]
    ds_read_b128 v[188:191], v9 offset:2560
    v_mfma_f32_16x16x32_bf16 v[88:91], v[152:155], v[160:163], v[88:91]
    ds_read_b128 v[192:195], v9 offset:3072
    v_mfma_f32_16x16x32_bf16 v[120:123], v[152:155], v[164:167], v[120:123]
    v_mfma_f32_16x16x32_bf16 v[92:95], v[156:159], v[160:163], v[92:95]
    ds_read_b128 v[196:199], v9 offset:3584
    v_mfma_f32_16x16x32_bf16 v[124:127], v[156:159], v[164:167], v[124:127]
    s_barrier
    s_waitcnt lgkmcnt(0)
    v_mfma_f32_16x16x32_bf16 v[64:67], v[168:171], v[200:203], v[64:67]
    ds_read_b128 v[160:163], v20 offset:0
    v_mfma_f32_16x16x32_bf16 v[96:99], v[168:171], v[204:207], v[96:99]
    ds_read_b128 v[164:167], v20 offset:2048
    v_mfma_f32_16x16x32_bf16 v[68:71], v[172:175], v[200:203], v[68:71]
    v_mfma_f32_16x16x32_bf16 v[100:103], v[172:175], v[204:207], v[100:103]
    ds_read_b128 v[128:131], v10 offset:0
    v_mfma_f32_16x16x32_bf16 v[72:75], v[176:179], v[200:203], v[72:75]
    ds_read_b128 v[132:135], v10 offset:512
    v_mfma_f32_16x16x32_bf16 v[104:107], v[176:179], v[204:207], v[104:107]
    v_mfma_f32_16x16x32_bf16 v[76:79], v[180:183], v[200:203], v[76:79]
    ds_read_b128 v[136:139], v10 offset:1024
    v_mfma_f32_16x16x32_bf16 v[108:111], v[180:183], v[204:207], v[108:111]
    v_mfma_f32_16x16x32_bf16 v[80:83], v[184:187], v[200:203], v[80:83]
    ds_read_b128 v[140:143], v10 offset:1536
    v_mfma_f32_16x16x32_bf16 v[112:115], v[184:187], v[204:207], v[112:115]
    ds_read_b128 v[144:147], v10 offset:2048
    v_mfma_f32_16x16x32_bf16 v[84:87], v[188:191], v[200:203], v[84:87]
    v_mfma_f32_16x16x32_bf16 v[116:119], v[188:191], v[204:207], v[116:119]
    ds_read_b128 v[148:151], v10 offset:2560
    v_mfma_f32_16x16x32_bf16 v[88:91], v[192:195], v[200:203], v[88:91]
    ds_read_b128 v[152:155], v10 offset:3072
    v_mfma_f32_16x16x32_bf16 v[120:123], v[192:195], v[204:207], v[120:123]
    v_mfma_f32_16x16x32_bf16 v[92:95], v[196:199], v[200:203], v[92:95]
    ds_read_b128 v[156:159], v10 offset:3584
    v_mfma_f32_16x16x32_bf16 v[124:127], v[196:199], v[204:207], v[124:127]
    s_waitcnt lgkmcnt(0)
    v_mfma_f32_16x16x32_bf16 v[64:67], v[128:131], v[160:163], v[64:67]
    ds_read_b128 v[200:203], v21 offset:0
    v_mfma_f32_16x16x32_bf16 v[96:99], v[128:131], v[164:167], v[96:99]
    ds_read_b128 v[204:207], v21 offset:2048
    v_mfma_f32_16x16x32_bf16 v[68:71], v[132:135], v[160:163], v[68:71]
    v_mfma_f32_16x16x32_bf16 v[100:103], v[132:135], v[164:167], v[100:103]
    ds_read_b128 v[168:171], v11 offset:0
    v_mfma_f32_16x16x32_bf16 v[72:75], v[136:139], v[160:163], v[72:75]
    ds_read_b128 v[172:175], v11 offset:512
    v_mfma_f32_16x16x32_bf16 v[104:107], v[136:139], v[164:167], v[104:107]
    v_mfma_f32_16x16x32_bf16 v[76:79], v[140:143], v[160:163], v[76:79]
    ds_read_b128 v[176:179], v11 offset:1024
    v_mfma_f32_16x16x32_bf16 v[108:111], v[140:143], v[164:167], v[108:111]
    v_mfma_f32_16x16x32_bf16 v[80:83], v[144:147], v[160:163], v[80:83]
    ds_read_b128 v[180:183], v11 offset:1536
    v_mfma_f32_16x16x32_bf16 v[112:115], v[144:147], v[164:167], v[112:115]
    ds_read_b128 v[184:187], v11 offset:2048
    v_mfma_f32_16x16x32_bf16 v[84:87], v[148:151], v[160:163], v[84:87]
    v_mfma_f32_16x16x32_bf16 v[116:119], v[148:151], v[164:167], v[116:119]
    ds_read_b128 v[188:191], v11 offset:2560
    v_mfma_f32_16x16x32_bf16 v[88:91], v[152:155], v[160:163], v[88:91]
    ds_read_b128 v[192:195], v11 offset:3072
    v_mfma_f32_16x16x32_bf16 v[120:123], v[152:155], v[164:167], v[120:123]
    v_mfma_f32_16x16x32_bf16 v[92:95], v[156:159], v[160:163], v[92:95]
    ds_read_b128 v[196:199], v11 offset:3584
    v_mfma_f32_16x16x32_bf16 v[124:127], v[156:159], v[164:167], v[124:127]
    s_barrier
    s_waitcnt lgkmcnt(0)
    v_mfma_f32_16x16x32_bf16 v[64:67], v[168:171], v[200:203], v[64:67]
    ds_read_b128 v[160:163], v22 offset:0
    v_mfma_f32_16x16x32_bf16 v[96:99], v[168:171], v[204:207], v[96:99]
    ds_read_b128 v[164:167], v22 offset:2048
    v_mfma_f32_16x16x32_bf16 v[68:71], v[172:175], v[200:203], v[68:71]
    v_mfma_f32_16x16x32_bf16 v[100:103], v[172:175], v[204:207], v[100:103]
    ds_read_b128 v[128:131], v12 offset:0
    v_mfma_f32_16x16x32_bf16 v[72:75], v[176:179], v[200:203], v[72:75]
    ds_read_b128 v[132:135], v12 offset:512
    v_mfma_f32_16x16x32_bf16 v[104:107], v[176:179], v[204:207], v[104:107]
    v_mfma_f32_16x16x32_bf16 v[76:79], v[180:183], v[200:203], v[76:79]
    ds_read_b128 v[136:139], v12 offset:1024
    v_mfma_f32_16x16x32_bf16 v[108:111], v[180:183], v[204:207], v[108:111]
    v_mfma_f32_16x16x32_bf16 v[80:83], v[184:187], v[200:203], v[80:83]
    ds_read_b128 v[140:143], v12 offset:1536
    v_mfma_f32_16x16x32_bf16 v[112:115], v[184:187], v[204:207], v[112:115]
    ds_read_b128 v[144:147], v12 offset:2048
    v_mfma_f32_16x16x32_bf16 v[84:87], v[188:191], v[200:203], v[84:87]
    v_mfma_f32_16x16x32_bf16 v[116:119], v[188:191], v[204:207], v[116:119]
    ds_read_b128 v[148:151], v12 offset:2560
    v_mfma_f32_16x16x32_bf16 v[88:91], v[192:195], v[200:203], v[88:91]
    ds_read_b128 v[152:155], v12 offset:3072
    v_mfma_f32_16x16x32_bf16 v[120:123], v[192:195], v[204:207], v[120:123]
    v_mfma_f32_16x16x32_bf16 v[92:95], v[196:199], v[200:203], v[92:95]
    ds_read_b128 v[156:159], v12 offset:3584
    v_mfma_f32_16x16x32_bf16 v[124:127], v[196:199], v[204:207], v[124:127]
    s_waitcnt lgkmcnt(0)
    v_mfma_f32_16x16x32_bf16 v[64:67], v[128:131], v[160:163], v[64:67]
    ds_read_b128 v[200:203], v23 offset:0
    v_mfma_f32_16x16x32_bf16 v[96:99], v[128:131], v[164:167], v[96:99]
    ds_read_b128 v[204:207], v23 offset:2048
    v_mfma_f32_16x16x32_bf16 v[68:71], v[132:135], v[160:163], v[68:71]
    v_mfma_f32_16x16x32_bf16 v[100:103], v[132:135], v[164:167], v[100:103]
    ds_read_b128 v[168:171], v13 offset:0
    v_mfma_f32_16x16x32_bf16 v[72:75], v[136:139], v[160:163], v[72:75]
    ds_read_b128 v[172:175], v13 offset:512
    v_mfma_f32_16x16x32_bf16 v[104:107], v[136:139], v[164:167], v[104:107]
    v_mfma_f32_16x16x32_bf16 v[76:79], v[140:143], v[160:163], v[76:79]
    ds_read_b128 v[176:179], v13 offset:1024
    v_mfma_f32_16x16x32_bf16 v[108:111], v[140:143], v[164:167], v[108:111]
    v_mfma_f32_16x16x32_bf16 v[80:83], v[144:147], v[160:163], v[80:83]
    ds_read_b128 v[180:183], v13 offset:1536
    v_mfma_f32_16x16x32_bf16 v[112:115], v[144:147], v[164:167], v[112:115]
    ds_read_b128 v[184:187], v13 offset:2048
    v_mfma_f32_16x16x32_bf16 v[84:87], v[148:151], v[160:163], v[84:87]
    v_mfma_f32_16x16x32_bf16 v[116:119], v[148:151], v[164:167], v[116:119]
    ds_read_b128 v[188:191], v13 offset:2560
    v_mfma_f32_16x16x32_bf16 v[88:91], v[152:155], v[160:163], v[88:91]
    ds_read_b128 v[192:195], v13 offset:3072
    v_mfma_f32_16x16x32_bf16 v[120:123], v[152:155], v[164:167], v[120:123]
    v_mfma_f32_16x16x32_bf16 v[92:95], v[156:159], v[160:163], v[92:95]
    ds_read_b128 v[196:199], v13 offset:3584
    v_mfma_f32_16x16x32_bf16 v[124:127], v[156:159], v[164:167], v[124:127]
    s_barrier
    s_waitcnt lgkmcnt(0)
    v_mfma_f32_16x16x32_bf16 v[64:67], v[168:171], v[200:203], v[64:67]
    ds_read_b128 v[160:163], v24 offset:0
    v_mfma_f32_16x16x32_bf16 v[96:99], v[168:171], v[204:207], v[96:99]
    ds_read_b128 v[164:167], v24 offset:2048
    v_mfma_f32_16x16x32_bf16 v[68:71], v[172:175], v[200:203], v[68:71]
    v_mfma_f32_16x16x32_bf16 v[100:103], v[172:175], v[204:207], v[100:103]
    ds_read_b128 v[128:131], v14 offset:0
    v_mfma_f32_16x16x32_bf16 v[72:75], v[176:179], v[200:203], v[72:75]
    ds_read_b128 v[132:135], v14 offset:512
    v_mfma_f32_16x16x32_bf16 v[104:107], v[176:179], v[204:207], v[104:107]
    v_mfma_f32_16x16x32_bf16 v[76:79], v[180:183], v[200:203], v[76:79]
    ds_read_b128 v[136:139], v14 offset:1024
    v_mfma_f32_16x16x32_bf16 v[108:111], v[180:183], v[204:207], v[108:111]
    v_mfma_f32_16x16x32_bf16 v[80:83], v[184:187], v[200:203], v[80:83]
    ds_read_b128 v[140:143], v14 offset:1536
    v_mfma_f32_16x16x32_bf16 v[112:115], v[184:187], v[204:207], v[112:115]
    ds_read_b128 v[144:147], v14 offset:2048
    v_mfma_f32_16x16x32_bf16 v[84:87], v[188:191], v[200:203], v[84:87]
    v_mfma_f32_16x16x32_bf16 v[116:119], v[188:191], v[204:207], v[116:119]
    ds_read_b128 v[148:151], v14 offset:2560
    v_mfma_f32_16x16x32_bf16 v[88:91], v[192:195], v[200:203], v[88:91]
    ds_read_b128 v[152:155], v14 offset:3072
    v_mfma_f32_16x16x32_bf16 v[120:123], v[192:195], v[204:207], v[120:123]
    v_mfma_f32_16x16x32_bf16 v[92:95], v[196:199], v[200:203], v[92:95]
    ds_read_b128 v[156:159], v14 offset:3584
    v_mfma_f32_16x16x32_bf16 v[124:127], v[196:199], v[204:207], v[124:127]
    s_waitcnt lgkmcnt(0)
    v_mfma_f32_16x16x32_bf16 v[64:67], v[128:131], v[160:163], v[64:67]
    ds_read_b128 v[200:203], v25 offset:0
    v_mfma_f32_16x16x32_bf16 v[96:99], v[128:131], v[164:167], v[96:99]
    ds_read_b128 v[204:207], v25 offset:2048
    v_mfma_f32_16x16x32_bf16 v[68:71], v[132:135], v[160:163], v[68:71]
    v_mfma_f32_16x16x32_bf16 v[100:103], v[132:135], v[164:167], v[100:103]
    ds_read_b128 v[168:171], v15 offset:0
    v_mfma_f32_16x16x32_bf16 v[72:75], v[136:139], v[160:163], v[72:75]
    ds_read_b128 v[172:175], v15 offset:512
    v_mfma_f32_16x16x32_bf16 v[104:107], v[136:139], v[164:167], v[104:107]
    v_mfma_f32_16x16x32_bf16 v[76:79], v[140:143], v[160:163], v[76:79]
    ds_read_b128 v[176:179], v15 offset:1024
    v_mfma_f32_16x16x32_bf16 v[108:111], v[140:143], v[164:167], v[108:111]
    v_mfma_f32_16x16x32_bf16 v[80:83], v[144:147], v[160:163], v[80:83]
    ds_read_b128 v[180:183], v15 offset:1536
    v_mfma_f32_16x16x32_bf16 v[112:115], v[144:147], v[164:167], v[112:115]
    ds_read_b128 v[184:187], v15 offset:2048
    v_mfma_f32_16x16x32_bf16 v[84:87], v[148:151], v[160:163], v[84:87]
    v_mfma_f32_16x16x32_bf16 v[116:119], v[148:151], v[164:167], v[116:119]
    ds_read_b128 v[188:191], v15 offset:2560
    v_mfma_f32_16x16x32_bf16 v[88:91], v[152:155], v[160:163], v[88:91]
    ds_read_b128 v[192:195], v15 offset:3072
    v_mfma_f32_16x16x32_bf16 v[120:123], v[152:155], v[164:167], v[120:123]
    v_mfma_f32_16x16x32_bf16 v[92:95], v[156:159], v[160:163], v[92:95]
    ds_read_b128 v[196:199], v15 offset:3584
    v_mfma_f32_16x16x32_bf16 v[124:127], v[156:159], v[164:167], v[124:127]
    s_waitcnt lgkmcnt(0)
    s_barrier
    v_mfma_f32_16x16x32_bf16 v[64:67], v[168:171], v[200:203], v[64:67]
    v_mfma_f32_16x16x32_bf16 v[96:99], v[168:171], v[204:207], v[96:99]
    v_mfma_f32_16x16x32_bf16 v[68:71], v[172:175], v[200:203], v[68:71]
    v_mfma_f32_16x16x32_bf16 v[100:103], v[172:175], v[204:207], v[100:103]
    v_mfma_f32_16x16x32_bf16 v[72:75], v[176:179], v[200:203], v[72:75]
    v_mfma_f32_16x16x32_bf16 v[104:107], v[176:179], v[204:207], v[104:107]
    v_mfma_f32_16x16x32_bf16 v[76:79], v[180:183], v[200:203], v[76:79]
    v_mfma_f32_16x16x32_bf16 v[108:111], v[180:183], v[204:207], v[108:111]
    v_mfma_f32_16x16x32_bf16 v[80:83], v[184:187], v[200:203], v[80:83]
    v_mfma_f32_16x16x32_bf16 v[112:115], v[184:187], v[204:207], v[112:115]
    v_mfma_f32_16x16x32_bf16 v[84:87], v[188:191], v[200:203], v[84:87]
    v_mfma_f32_16x16x32_bf16 v[116:119], v[188:191], v[204:207], v[116:119]
    v_mfma_f32_16x16x32_bf16 v[88:91], v[192:195], v[200:203], v[88:91]
    v_mfma_f32_16x16x32_bf16 v[120:123], v[192:195], v[204:207], v[120:123]
    v_mfma_f32_16x16x32_bf16 v[92:95], v[196:199], v[200:203], v[92:95]
    v_mfma_f32_16x16x32_bf16 v[124:127], v[196:199], v[204:207], v[124:127]
    s_nop 9
    v_fma_f32 v65, v32, v64, v65
    v_fma_f32 v97, v32, v96, v97
    v_fma_f32 v65, -v33, v96, v65
    v_fma_f32 v97, v33, v64, v97
    v_fma_f32 v66, v32, v65, v66
    v_fma_f32 v98, v32, v97, v98
    v_fma_f32 v66, -v33, v97, v66
    v_fma_f32 v98, v33, v65, v98
    v_fma_f32 v67, v32, v66, v67
    v_fma_f32 v99, v32, v98, v99
    v_fma_f32 v67, -v33, v98, v67
    v_fma_f32 v99, v33, v66, v99
    v_fma_f32 v68, v32, v67, v68
    v_fma_f32 v100, v32, v99, v100
    v_fma_f32 v68, -v33, v99, v68
    v_fma_f32 v100, v33, v67, v100
    v_fma_f32 v69, v32, v68, v69
    v_fma_f32 v101, v32, v100, v101
    v_fma_f32 v69, -v33, v100, v69
    v_fma_f32 v101, v33, v68, v101
    v_fma_f32 v70, v32, v69, v70
    v_fma_f32 v102, v32, v101, v102
    v_fma_f32 v70, -v33, v101, v70
    v_fma_f32 v102, v33, v69, v102
    v_fma_f32 v71, v32, v70, v71
    v_fma_f32 v103, v32, v102, v103
    v_fma_f32 v71, -v33, v102, v71
    v_fma_f32 v103, v33, v70, v103
    v_fma_f32 v72, v32, v71, v72
    v_fma_f32 v104, v32, v103, v104
    v_fma_f32 v72, -v33, v103, v72
    v_fma_f32 v104, v33, v71, v104
    v_fma_f32 v73, v32, v72, v73
    v_fma_f32 v105, v32, v104, v105
    v_fma_f32 v73, -v33, v104, v73
    v_fma_f32 v105, v33, v72, v105
    v_fma_f32 v74, v32, v73, v74
    v_fma_f32 v106, v32, v105, v106
    v_fma_f32 v74, -v33, v105, v74
    v_fma_f32 v106, v33, v73, v106
    v_fma_f32 v75, v32, v74, v75
    v_fma_f32 v107, v32, v106, v107
    v_fma_f32 v75, -v33, v106, v75
    v_fma_f32 v107, v33, v74, v107
    v_fma_f32 v76, v32, v75, v76
    v_fma_f32 v108, v32, v107, v108
    v_fma_f32 v76, -v33, v107, v76
    v_fma_f32 v108, v33, v75, v108
    v_fma_f32 v77, v32, v76, v77
    v_fma_f32 v109, v32, v108, v109
    v_fma_f32 v77, -v33, v108, v77
    v_fma_f32 v109, v33, v76, v109
    v_fma_f32 v78, v32, v77, v78
    v_fma_f32 v110, v32, v109, v110
    v_fma_f32 v78, -v33, v109, v78
    v_fma_f32 v110, v33, v77, v110
    v_fma_f32 v79, v32, v78, v79
    v_fma_f32 v111, v32, v110, v111
    v_fma_f32 v79, -v33, v110, v79
    v_fma_f32 v111, v33, v78, v111
    v_fma_f32 v80, v32, v79, v80
    v_fma_f32 v112, v32, v111, v112
    v_fma_f32 v80, -v33, v111, v80
    v_fma_f32 v112, v33, v79, v112
    v_fma_f32 v81, v32, v80, v81
    v_fma_f32 v113, v32, v112, v113
    v_fma_f32 v81, -v33, v112, v81
    v_fma_f32 v113, v33, v80, v113
    v_fma_f32 v82, v32, v81, v82
    v_fma_f32 v114, v32, v113, v114
    v_fma_f32 v82, -v33, v113, v82
    v_fma_f32 v114, v33, v81, v114
    v_fma_f32 v83, v32, v82, v83
    v_fma_f32 v115, v32, v114, v115
    v_fma_f32 v83, -v33, v114, v83
    v_fma_f32 v115, v33, v82, v115
    v_fma_f32 v84, v32, v83, v84
    v_fma_f32 v116, v32, v115, v116
    v_fma_f32 v84, -v33, v115, v84
    v_fma_f32 v116, v33, v83, v116
    v_fma_f32 v85, v32, v84, v85
    v_fma_f32 v117, v32, v116, v117
    v_fma_f32 v85, -v33, v116, v85
    v_fma_f32 v117, v33, v84, v117
    v_fma_f32 v86, v32, v85, v86
    v_fma_f32 v118, v32, v117, v118
    v_fma_f32 v86, -v33, v117, v86
    v_fma_f32 v118, v33, v85, v118
    v_fma_f32 v87, v32, v86, v87
    v_fma_f32 v119, v32, v118, v119
    v_fma_f32 v87, -v33, v118, v87
    v_fma_f32 v119, v33, v86, v119
    v_fma_f32 v88, v32, v87, v88
    v_fma_f32 v120, v32, v119, v120
    v_fma_f32 v88, -v33, v119, v88
    v_fma_f32 v120, v33, v87, v120
    v_fma_f32 v89, v32, v88, v89
    v_fma_f32 v121, v32, v120, v121
    v_fma_f32 v89, -v33, v120, v89
    v_fma_f32 v121, v33, v88, v121
    v_fma_f32 v90, v32, v89, v90
    v_fma_f32 v122, v32, v121, v122
    v_fma_f32 v90, -v33, v121, v90
    v_fma_f32 v122, v33, v89, v122
    v_fma_f32 v91, v32, v90, v91
    v_fma_f32 v123, v32, v122, v123
    v_fma_f32 v91, -v33, v122, v91
    v_fma_f32 v123, v33, v90, v123
    v_fma_f32 v92, v32, v91, v92
    v_fma_f32 v124, v32, v123, v124
    v_fma_f32 v92, -v33, v123, v92
    v_fma_f32 v124, v33, v91, v124
    v_fma_f32 v93, v32, v92, v93
    v_fma_f32 v125, v32, v124, v125
    v_fma_f32 v93, -v33, v124, v93
    v_fma_f32 v125, v33, v92, v125
    v_fma_f32 v94, v32, v93, v94
    v_fma_f32 v126, v32, v125, v126
    v_fma_f32 v94, -v33, v125, v94
    v_fma_f32 v126, v33, v93, v126
    v_fma_f32 v95, v32, v94, v95
    v_fma_f32 v127, v32, v126, v127
    v_fma_f32 v95, -v33, v126, v95
    v_fma_f32 v127, v33, v94, v127
    v_mov_b32 v44, v95
    v_mov_b32 v46, v95
    v_mov_b32 v45, v127
    v_mov_b32 v47, v127
    s_nop 1
    v_permlane16_swap_b32 v44, v46
    v_permlane16_swap_b32 v45, v47
    s_nop 1
    v_mov_b32 v48, v44
    v_mov_b32 v49, v45
    v_mov_b32 v52, v46
    v_mov_b32 v53, v47
    s_nop 1
    v_permlane32_swap_b32 v44, v48
    v_permlane32_swap_b32 v45, v49
    v_permlane32_swap_b32 v46, v52
    v_permlane32_swap_b32 v47, v53
    s_nop 1
    v_fma_f32 v46, v34, v44, v46
    v_fma_f32 v47, v34, v45, v47
    v_fma_f32 v46, -v35, v45, v46
    v_fma_f32 v47, v35, v44, v47
    v_fma_f32 v48, v34, v46, v48
    v_fma_f32 v49, v34, v47, v49
    v_fma_f32 v48, -v35, v47, v48
    v_fma_f32 v49, v35, v46, v49
    v_fma_f32 v52, v34, v48, v52
    v_fma_f32 v53, v34, v49, v53
    v_fma_f32 v52, -v35, v49, v52
    v_fma_f32 v53, v35, v48, v53
    v_mov_b32 v54, s40
    v_mov_b32 v55, s41
    v_lshlrev_b32 v7, 4, v30
    s_lshl_b32 s42, s4, 13
    s_add_u32 s46, s42, 0x0
    v_cmp_eq_u32 vcc, 3, v3
    s_and_saveexec_b64 s[52:53], vcc
    buffer_store_dwordx4 v[52:55], v7, s[20:23], s46 offen sc1
    s_mov_b64 exec, s[52:53]
    v_cndmask_b32 v42, 0, v48, vcc
    v_cndmask_b32 v43, 0, v49, vcc
    v_cmp_eq_u32 vcc, 2, v3
    v_cndmask_b32 v42, v42, v46, vcc
    v_cndmask_b32 v43, v43, v47, vcc
    v_cmp_eq_u32 vcc, 1, v3
    v_cndmask_b32 v42, v42, v44, vcc
    v_cndmask_b32 v43, v43, v45, vcc
    s_sub_u32 s42, s4, 1
    v_sub_u32 v208, s42, v3
    v_cmp_gt_i32 s[54:55], 0, v208
    v_max_i32 v208, 0, v208
    v_lshl_add_u32 v208, v208, 13, v7
    s_sub_u32 s42, s4, 5
    v_sub_u32 v209, s42, v3
    v_cmp_gt_i32 s[64:65], 0, v209
    v_max_i32 v209, 0, v209
    v_lshl_add_u32 v209, v209, 13, v7
    s_sub_u32 s42, s4, 9
    v_sub_u32 v210, s42, v3
    v_cmp_gt_i32 s[66:67], 0, v210
    v_max_i32 v210, 0, v210
    v_lshl_add_u32 v210, v210, 13, v7
    s_sub_u32 s42, s4, 13
    v_sub_u32 v211, s42, v3
    v_cmp_gt_i32 s[68:69], 0, v211
    v_max_i32 v211, 0, v211
    v_lshl_add_u32 v211, v211, 13, v7
    s_mov_b32 s46, 0x0
    v_mul_f32 v50, v64, v36
    v_mul_f32 v51, v64, v37
    v_fma_f32 v50, -v96, v37, v50
    v_fma_f32 v96, v96, v36, v51
    v_mov_b32 v64, v50
    v_mul_f32 v52, v65, v36
    v_mul_f32 v53, v65, v37
    v_fma_f32 v52, -v97, v37, v52
    v_fma_f32 v97, v97, v36, v53
    v_mov_b32 v65, v52
    v_mul_f32 v50, v66, v36
    v_mul_f32 v51, v66, v37
    v_fma_f32 v50, -v98, v37, v50
    v_fma_f32 v98, v98, v36, v51
    v_mov_b32 v66, v50
    v_mul_f32 v52, v67, v36
    v_mul_f32 v53, v67, v37
    v_fma_f32 v52, -v99, v37, v52
    v_fma_f32 v99, v99, v36, v53
    v_mov_b32 v67, v52
    v_mul_f32 v50, v68, v36
    v_mul_f32 v51, v68, v37
    v_fma_f32 v50, -v100, v37, v50
    v_fma_f32 v100, v100, v36, v51
    v_mov_b32 v68, v50
    v_mul_f32 v52, v69, v36
    v_mul_f32 v53, v69, v37
    v_fma_f32 v52, -v101, v37, v52
    v_fma_f32 v101, v101, v36, v53
    v_mov_b32 v69, v52
    v_mul_f32 v50, v70, v36
    v_mul_f32 v51, v70, v37
    v_fma_f32 v50, -v102, v37, v50
    v_fma_f32 v102, v102, v36, v51
    v_mov_b32 v70, v50
    v_mul_f32 v52, v71, v36
    v_mul_f32 v53, v71, v37
    v_fma_f32 v52, -v103, v37, v52
    v_fma_f32 v103, v103, v36, v53
    v_mov_b32 v71, v52
    v_mul_f32 v50, v72, v36
    v_mul_f32 v51, v72, v37
    v_fma_f32 v50, -v104, v37, v50
    v_fma_f32 v104, v104, v36, v51
    v_mov_b32 v72, v50
    v_mul_f32 v52, v73, v36
    v_mul_f32 v53, v73, v37
    v_fma_f32 v52, -v105, v37, v52
    v_fma_f32 v105, v105, v36, v53
    v_mov_b32 v73, v52
    v_mul_f32 v50, v74, v36
    v_mul_f32 v51, v74, v37
    v_fma_f32 v50, -v106, v37, v50
    v_fma_f32 v106, v106, v36, v51
    v_mov_b32 v74, v50
    v_mul_f32 v52, v75, v36
    v_mul_f32 v53, v75, v37
    v_fma_f32 v52, -v107, v37, v52
    v_fma_f32 v107, v107, v36, v53
    v_mov_b32 v75, v52
    v_mul_f32 v50, v76, v36
    v_mul_f32 v51, v76, v37
    v_fma_f32 v50, -v108, v37, v50
    v_fma_f32 v108, v108, v36, v51
    v_mov_b32 v76, v50
    v_mul_f32 v52, v77, v36
    v_mul_f32 v53, v77, v37
    v_fma_f32 v52, -v109, v37, v52
    v_fma_f32 v109, v109, v36, v53
    v_mov_b32 v77, v52
    v_mul_f32 v50, v78, v36
    v_mul_f32 v51, v78, v37
    v_fma_f32 v50, -v110, v37, v50
    v_fma_f32 v110, v110, v36, v51
    v_mov_b32 v78, v50
    v_mul_f32 v52, v79, v36
    v_mul_f32 v53, v79, v37
    v_fma_f32 v52, -v111, v37, v52
    v_fma_f32 v111, v111, v36, v53
    v_mov_b32 v79, v52
    v_mul_f32 v50, v80, v36
    v_mul_f32 v51, v80, v37
    v_fma_f32 v50, -v112, v37, v50
    v_fma_f32 v112, v112, v36, v51
    v_mov_b32 v80, v50
    v_mul_f32 v52, v81, v36
    v_mul_f32 v53, v81, v37
    v_fma_f32 v52, -v113, v37, v52
    v_fma_f32 v113, v113, v36, v53
    v_mov_b32 v81, v52
    v_mul_f32 v50, v82, v36
    v_mul_f32 v51, v82, v37
    v_fma_f32 v50, -v114, v37, v50
    v_fma_f32 v114, v114, v36, v51
    v_mov_b32 v82, v50
    v_mul_f32 v52, v83, v36
    v_mul_f32 v53, v83, v37
    v_fma_f32 v52, -v115, v37, v52
    v_fma_f32 v115, v115, v36, v53
    v_mov_b32 v83, v52
    v_mul_f32 v50, v84, v36
    v_mul_f32 v51, v84, v37
    v_fma_f32 v50, -v116, v37, v50
    v_fma_f32 v116, v116, v36, v51
    v_mov_b32 v84, v50
    v_mul_f32 v52, v85, v36
    v_mul_f32 v53, v85, v37
    v_fma_f32 v52, -v117, v37, v52
    v_fma_f32 v117, v117, v36, v53
    v_mov_b32 v85, v52
    v_mul_f32 v50, v86, v36
    v_mul_f32 v51, v86, v37
    v_fma_f32 v50, -v118, v37, v50
    v_fma_f32 v118, v118, v36, v51
    v_mov_b32 v86, v50
    v_mul_f32 v52, v87, v36
    v_mul_f32 v53, v87, v37
    v_fma_f32 v52, -v119, v37, v52
    v_fma_f32 v119, v119, v36, v53
    v_mov_b32 v87, v52
    v_mul_f32 v50, v88, v36
    v_mul_f32 v51, v88, v37
    v_fma_f32 v50, -v120, v37, v50
    v_fma_f32 v120, v120, v36, v51
    v_mov_b32 v88, v50
    v_mul_f32 v52, v89, v36
    v_mul_f32 v53, v89, v37
    v_fma_f32 v52, -v121, v37, v52
    v_fma_f32 v121, v121, v36, v53
    v_mov_b32 v89, v52
    v_mul_f32 v50, v90, v36
    v_mul_f32 v51, v90, v37
    v_fma_f32 v50, -v122, v37, v50
    v_fma_f32 v122, v122, v36, v51
    v_mov_b32 v90, v50
    v_mul_f32 v52, v91, v36
    v_mul_f32 v53, v91, v37
    v_fma_f32 v52, -v123, v37, v52
    v_fma_f32 v123, v123, v36, v53
    v_mov_b32 v91, v52
    v_mul_f32 v50, v92, v36
    v_mul_f32 v51, v92, v37
    v_fma_f32 v50, -v124, v37, v50
    v_fma_f32 v124, v124, v36, v51
    v_mov_b32 v92, v50
    v_mul_f32 v52, v93, v36
    v_mul_f32 v53, v93, v37
    v_fma_f32 v52, -v125, v37, v52
    v_fma_f32 v125, v125, v36, v53
    v_mov_b32 v93, v52
    v_mul_f32 v50, v94, v36
    v_mul_f32 v51, v94, v37
    v_fma_f32 v50, -v126, v37, v50
    v_fma_f32 v126, v126, v36, v51
    v_mov_b32 v94, v50
    v_mul_f32 v52, v95, v36
    v_mul_f32 v53, v95, v37
    v_fma_f32 v52, -v127, v37, v52
    v_fma_f32 v127, v127, v36, v53
    v_mov_b32 v95, v52
    s_mov_b32 s47, 0
    v_mov_b32 v128, v32
    v_mov_b32 v160, v33
    v_mul_f32 v129, v32, v128
    v_mul_f32 v161, v32, v160
    v_fma_f32 v129, -v33, v160, v129
    v_fma_f32 v161, v33, v128, v161
    v_mul_f32 v130, v32, v129
    v_mul_f32 v162, v32, v161
    v_fma_f32 v130, -v33, v161, v130
    v_fma_f32 v162, v33, v129, v162
    v_mul_f32 v131, v32, v130
    v_mul_f32 v163, v32, v162
    v_fma_f32 v131, -v33, v162, v131
    v_fma_f32 v163, v33, v130, v163
    v_mul_f32 v132, v32, v131
    v_mul_f32 v164, v32, v163
    v_fma_f32 v132, -v33, v163, v132
    v_fma_f32 v164, v33, v131, v164
    v_mul_f32 v133, v32, v132
    v_mul_f32 v165, v32, v164
    v_fma_f32 v133, -v33, v164, v133
    v_fma_f32 v165, v33, v132, v165
    v_mul_f32 v134, v32, v133
    v_mul_f32 v166, v32, v165
    v_fma_f32 v134, -v33, v165, v134
    v_fma_f32 v166, v33, v133, v166
    v_mul_f32 v135, v32, v134
    v_mul_f32 v167, v32, v166
    v_fma_f32 v135, -v33, v166, v135
    v_fma_f32 v167, v33, v134, v167
    v_mul_f32 v136, v32, v135
    v_mul_f32 v168, v32, v167
    v_fma_f32 v136, -v33, v167, v136
    v_fma_f32 v168, v33, v135, v168
    v_mul_f32 v137, v32, v136
    v_mul_f32 v169, v32, v168
    v_fma_f32 v137, -v33, v168, v137
    v_fma_f32 v169, v33, v136, v169
    v_mul_f32 v138, v32, v137
    v_mul_f32 v170, v32, v169
    v_fma_f32 v138, -v33, v169, v138
    v_fma_f32 v170, v33, v137, v170
    v_mul_f32 v139, v32, v138
    v_mul_f32 v171, v32, v170
    v_fma_f32 v139, -v33, v170, v139
    v_fma_f32 v171, v33, v138, v171
    v_mul_f32 v140, v32, v139
    v_mul_f32 v172, v32, v171
    v_fma_f32 v140, -v33, v171, v140
    v_fma_f32 v172, v33, v139, v172
    v_mul_f32 v141, v32, v140
    v_mul_f32 v173, v32, v172
    v_fma_f32 v141, -v33, v172, v141
    v_fma_f32 v173, v33, v140, v173
    v_mul_f32 v142, v32, v141
    v_mul_f32 v174, v32, v173
    v_fma_f32 v142, -v33, v173, v142
    v_fma_f32 v174, v33, v141, v174
    v_mul_f32 v143, v32, v142
    v_mul_f32 v175, v32, v174
    v_fma_f32 v143, -v33, v174, v143
    v_fma_f32 v175, v33, v142, v175
    s_cmp_le_u32 s4, 0
    s_cbranch_scc1 ESI_1
    buffer_load_dwordx4 v[192:195], v208, s[20:23], s46 offen sc1
    s_cmp_le_u32 s4, 4
    s_cbranch_scc1 ESI_1
    buffer_load_dwordx4 v[196:199], v209, s[20:23], s46 offen sc1
    s_cmp_le_u32 s4, 8
    s_cbranch_scc1 ESI_1
    buffer_load_dwordx4 v[200:203], v210, s[20:23], s46 offen sc1
    s_cmp_le_u32 s4, 12
    s_cbranch_scc1 ESI_1
    buffer_load_dwordx4 v[204:207], v211, s[20:23], s46 offen sc1
ESI_1:
    v_mul_f32 v144, v32, v143
    v_mul_f32 v176, v32, v175
    v_fma_f32 v144, -v33, v175, v144
    v_fma_f32 v176, v33, v143, v176
    v_mul_f32 v145, v32, v144
    v_mul_f32 v177, v32, v176
    v_fma_f32 v145, -v33, v176, v145
    v_fma_f32 v177, v33, v144, v177
    v_mul_f32 v146, v32, v145
    v_mul_f32 v178, v32, v177
    v_fma_f32 v146, -v33, v177, v146
    v_fma_f32 v178, v33, v145, v178
    v_mul_f32 v147, v32, v146
    v_mul_f32 v179, v32, v178
    v_fma_f32 v147, -v33, v178, v147
    v_fma_f32 v179, v33, v146, v179
    v_mul_f32 v148, v32, v147
    v_mul_f32 v180, v32, v179
    v_fma_f32 v148, -v33, v179, v148
    v_fma_f32 v180, v33, v147, v180
    v_mul_f32 v149, v32, v148
    v_mul_f32 v181, v32, v180
    v_fma_f32 v149, -v33, v180, v149
    v_fma_f32 v181, v33, v148, v181
    v_mul_f32 v150, v32, v149
    v_mul_f32 v182, v32, v181
    v_fma_f32 v150, -v33, v181, v150
    v_fma_f32 v182, v33, v149, v182
    v_mul_f32 v151, v32, v150
    v_mul_f32 v183, v32, v182
    v_fma_f32 v151, -v33, v182, v151
    v_fma_f32 v183, v33, v150, v183
    v_mul_f32 v152, v32, v151
    v_mul_f32 v184, v32, v183
    v_fma_f32 v152, -v33, v183, v152
    v_fma_f32 v184, v33, v151, v184
    v_mul_f32 v153, v32, v152
    v_mul_f32 v185, v32, v184
    v_fma_f32 v153, -v33, v184, v153
    v_fma_f32 v185, v33, v152, v185
    v_mul_f32 v154, v32, v153
    v_mul_f32 v186, v32, v185
    v_fma_f32 v154, -v33, v185, v154
    v_fma_f32 v186, v33, v153, v186
    v_mul_f32 v155, v32, v154
    v_mul_f32 v187, v32, v186
    v_fma_f32 v155, -v33, v186, v155
    v_fma_f32 v187, v33, v154, v187
    v_mul_f32 v156, v32, v155
    v_mul_f32 v188, v32, v187
    v_fma_f32 v156, -v33, v187, v156
    v_fma_f32 v188, v33, v155, v188
    v_mul_f32 v157, v32, v156
    v_mul_f32 v189, v32, v188
    v_fma_f32 v157, -v33, v188, v157
    v_fma_f32 v189, v33, v156, v189
    v_mul_f32 v158, v32, v157
    v_mul_f32 v190, v32, v189
    v_fma_f32 v158, -v33, v189, v158
    v_fma_f32 v190, v33, v157, v190
    v_mul_f32 v159, v32, v158
    v_mul_f32 v191, v32, v190
    v_fma_f32 v159, -v33, v190, v159
    v_fma_f32 v191, v33, v158, v191
    v_lshrrev_b32 v5, 2, v4
    v_lshrrev_b32 v6, 3, v4
    v_xor_b32 v5, v5, v6
    v_and_b32 v5, 1, v5
    v_and_b32 v6, 3, v4
    v_lshl_add_u32 v5, v5, 2, v6
    v_lshlrev_b32 v6, 1, v3
    v_xor_b32 v6, v6, v5
    s_lshl_b32 s42, s3, 13
    v_lshl_add_u32 v56, v4, 8, s42
    v_lshl_add_u32 v57, v6, 5, v56
    v_xor_b32 v6, 1, v6
    v_lshl_add_u32 v58, v6, 5, v56
    v_lshrrev_b32 v5, 2, v2
    v_and_b32 v5, 3, v5
    v_and_b32 v6, 3, v2
    v_lshl_add_u32 v59, v3, 3, v5
    v_lshlrev_b32 v59, 8, v59
    v_lshl_add_u32 v59, v6, 3, v59
    v_add_u32 v59, s42, v59
    v_and_b32 v6, 1, v3
    v_lshl_add_u32 v5, v6, 2, v5
    v_lshlrev_b32 v5, 5, v5
    v_mov_b32 v63, v5
    s_cmp_eq_u32 s47, 1
    s_cbranch_scc1 K1A_READY
    s_mov_b32 s47, 0
K1A_SWEEP:
    s_waitcnt vmcnt(0)
    v_cmp_eq_u32 vcc, s40, v194
    v_cmp_eq_u32 s[52:53], s41, v195
    s_and_b64 vcc, vcc, s[52:53]
    s_or_b64 s[48:49], vcc, s[54:55]
    v_cmp_eq_u32 vcc, s40, v198
    v_cmp_eq_u32 s[52:53], s41, v199
    s_and_b64 vcc, vcc, s[52:53]
    s_or_b64 vcc, vcc, s[64:65]
    s_and_b64 s[48:49], s[48:49], vcc
    v_cmp_eq_u32 vcc, s40, v202
    v_cmp_eq_u32 s[52:53], s41, v203
    s_and_b64 vcc, vcc, s[52:53]
    s_or_b64 vcc, vcc, s[66:67]
    s_and_b64 s[48:49], s[48:49], vcc
    v_cmp_eq_u32 vcc, s40, v206
    v_cmp_eq_u32 s[52:53], s41, v207
    s_and_b64 vcc, vcc, s[52:53]
    s_or_b64 vcc, vcc, s[68:69]
    s_and_b64 s[48:49], s[48:49], vcc
    s_cmp_eq_u64 s[48:49], -1
    s_cbranch_scc1 K1A_READY
    s_sleep 4
    s_cmp_le_u32 s4, 0
    s_cbranch_scc1 ESI_2
    buffer_load_dwordx4 v[192:195], v208, s[20:23], s46 offen sc1
    s_cmp_le_u32 s4, 4
    s_cbranch_scc1 ESI_2
    buffer_load_dwordx4 v[196:199], v209, s[20:23], s46 offen sc1
    s_cmp_le_u32 s4, 8
    s_cbranch_scc1 ESI_2
    buffer_load_dwordx4 v[200:203], v210, s[20:23], s46 offen sc1
    s_cmp_le_u32 s4, 12
    s_cbranch_scc1 ESI_2
    buffer_load_dwordx4 v[204:207], v211, s[20:23], s46 offen sc1
ESI_2:
    s_add_u32 s47, s47, 1
    s_cmp_lt_u32 s47, 0x20000
    s_cbranch_scc1 K1A_SWEEP
    s_waitcnt vmcnt(0)
K1A_READY:
    v_cndmask_b32 v192, v192, 0, s[54:55]
    v_cndmask_b32 v193, v193, 0, s[54:55]
    v_cndmask_b32 v196, v196, 0, s[64:65]
    v_cndmask_b32 v197, v197, 0, s[64:65]
    v_cndmask_b32 v200, v200, 0, s[66:67]
    v_cndmask_b32 v201, v201, 0, s[66:67]
    v_cndmask_b32 v204, v204, 0, s[68:69]
    v_cndmask_b32 v205, v205, 0, s[68:69]
    v_fma_f32 v200, v28, v204, v200
    v_fma_f32 v201, v28, v205, v201
    v_fma_f32 v200, -v29, v205, v200
    v_fma_f32 v201, v29, v204, v201
    v_fma_f32 v196, v28, v200, v196
    v_fma_f32 v197, v28, v201, v197
    v_fma_f32 v196, -v29, v201, v196
    v_fma_f32 v197, v29, v200, v197
    v_fma_f32 v192, v28, v196, v192
    v_fma_f32 v193, v28, v197, v193
    v_fma_f32 v192, -v29, v197, v192
    v_fma_f32 v193, v29, v196, v193
    v_mul_f32 v52, v192, v26
    v_mul_f32 v53, v192, v27
    v_fma_f32 v52, -v193, v27, v52
    v_fma_f32 v51, v193, v26, v53
    v_mov_b32 v50, v52
    v_mov_b32 v52, v50
    v_mov_b32 v53, v51
    s_nop 1
    v_permlane16_swap_b32 v50, v52
    v_permlane16_swap_b32 v51, v53
    s_nop 1
    v_add_f32 v50, v50, v52
    v_add_f32 v51, v51, v53
    v_mov_b32 v52, v50
    v_mov_b32 v53, v51
    s_nop 1
    v_permlane32_swap_b32 v50, v52
    v_permlane32_swap_b32 v51, v53
    s_nop 1
    v_add_f32 v50, v50, v52
    v_add_f32 v51, v51, v53
    v_mul_f32 v52, v50, v40
    v_mul_f32 v53, v50, v41
    v_fma_f32 v52, -v51, v41, v52
    v_fma_f32 v51, v51, v40, v53
    v_mov_b32 v50, v52
    v_add_f32 v50, v50, v42
    v_add_f32 v51, v51, v43
    v_mul_f32 v52, v50, v36
    v_mul_f32 v53, v50, v37
    v_fma_f32 v52, -v51, v37, v52
    v_fma_f32 v51, v51, v36, v53
    v_mov_b32 v50, v52
    s_lshl_b32 s42, s4, 3
    s_lshl_b32 s42, s42, 15
    s_lshl_b32 s43, s5, 2
    s_add_u32 s43, s43, s3
    s_lshl_b32 s43, s43, 10
    s_add_u32 s42, s42, s43
    s_add_u32 s42, s42, 0x400000
    v_lshlrev_b32 v7, 4, v2
    v_fma_f32 v64, v128, v50, v64
    v_fma_f32 v96, v128, v51, v96
    v_fma_f32 v64, -v160, v51, v64
    v_fma_f32 v96, v160, v50, v96
    v_fma_f32 v65, v129, v50, v65
    v_fma_f32 v97, v129, v51, v97
    v_fma_f32 v65, -v161, v51, v65
    v_fma_f32 v97, v161, v50, v97
    v_cvt_pk_bf16_f32 v192, v64, v65
    v_cvt_pk_bf16_f32 v208, -v96, -v97
    v_fma_f32 v66, v130, v50, v66
    v_fma_f32 v98, v130, v51, v98
    v_fma_f32 v66, -v162, v51, v66
    v_fma_f32 v98, v162, v50, v98
    v_fma_f32 v67, v131, v50, v67
    v_fma_f32 v99, v131, v51, v99
    v_fma_f32 v67, -v163, v51, v67
    v_fma_f32 v99, v163, v50, v99
    v_cvt_pk_bf16_f32 v193, v66, v67
    v_cvt_pk_bf16_f32 v209, -v98, -v99
    v_fma_f32 v68, v132, v50, v68
    v_fma_f32 v100, v132, v51, v100
    v_fma_f32 v68, -v164, v51, v68
    v_fma_f32 v100, v164, v50, v100
    v_fma_f32 v69, v133, v50, v69
    v_fma_f32 v101, v133, v51, v101
    v_fma_f32 v69, -v165, v51, v69
    v_fma_f32 v101, v165, v50, v101
    v_cvt_pk_bf16_f32 v194, v68, v69
    v_cvt_pk_bf16_f32 v210, -v100, -v101
    v_fma_f32 v70, v134, v50, v70
    v_fma_f32 v102, v134, v51, v102
    v_fma_f32 v70, -v166, v51, v70
    v_fma_f32 v102, v166, v50, v102
    v_fma_f32 v71, v135, v50, v71
    v_fma_f32 v103, v135, v51, v103
    v_fma_f32 v71, -v167, v51, v71
    v_fma_f32 v103, v167, v50, v103
    v_cvt_pk_bf16_f32 v195, v70, v71
    v_cvt_pk_bf16_f32 v211, -v102, -v103
    v_fma_f32 v72, v136, v50, v72
    v_fma_f32 v104, v136, v51, v104
    v_fma_f32 v72, -v168, v51, v72
    v_fma_f32 v104, v168, v50, v104
    v_fma_f32 v73, v137, v50, v73
    v_fma_f32 v105, v137, v51, v105
    v_fma_f32 v73, -v169, v51, v73
    v_fma_f32 v105, v169, v50, v105
    v_cvt_pk_bf16_f32 v196, v72, v73
    v_cvt_pk_bf16_f32 v212, -v104, -v105
    v_fma_f32 v74, v138, v50, v74
    v_fma_f32 v106, v138, v51, v106
    v_fma_f32 v74, -v170, v51, v74
    v_fma_f32 v106, v170, v50, v106
    v_fma_f32 v75, v139, v50, v75
    v_fma_f32 v107, v139, v51, v107
    v_fma_f32 v75, -v171, v51, v75
    v_fma_f32 v107, v171, v50, v107
    v_cvt_pk_bf16_f32 v197, v74, v75
    v_cvt_pk_bf16_f32 v213, -v106, -v107
    v_fma_f32 v76, v140, v50, v76
    v_fma_f32 v108, v140, v51, v108
    v_fma_f32 v76, -v172, v51, v76
    v_fma_f32 v108, v172, v50, v108
    v_fma_f32 v77, v141, v50, v77
    v_fma_f32 v109, v141, v51, v109
    v_fma_f32 v77, -v173, v51, v77
    v_fma_f32 v109, v173, v50, v109
    v_cvt_pk_bf16_f32 v198, v76, v77
    v_cvt_pk_bf16_f32 v214, -v108, -v109
    v_fma_f32 v78, v142, v50, v78
    v_fma_f32 v110, v142, v51, v110
    v_fma_f32 v78, -v174, v51, v78
    v_fma_f32 v110, v174, v50, v110
    v_fma_f32 v79, v143, v50, v79
    v_fma_f32 v111, v143, v51, v111
    v_fma_f32 v79, -v175, v51, v79
    v_fma_f32 v111, v175, v50, v111
    v_cvt_pk_bf16_f32 v199, v78, v79
    v_cvt_pk_bf16_f32 v215, -v110, -v111
    ds_write_b128 v57, v[192:195] offset:0
    ds_write_b128 v57, v[196:199] offset:16
    ds_write_b128 v57, v[208:211] offset:4096
    ds_write_b128 v57, v[212:215] offset:4112
    v_xor_b32 v5, 0, v63
    v_add_u32 v128, v59, v5
    v_xor_b32 v5, 128, v5
    v_add_u32 v129, v59, v5
    v_xor_b32 v5, 32, v63
    v_add_u32 v130, v59, v5
    v_xor_b32 v5, 128, v5
    v_add_u32 v131, v59, v5
    v_xor_b32 v5, 64, v63
    v_add_u32 v132, v59, v5
    v_xor_b32 v5, 128, v5
    v_add_u32 v133, v59, v5
    v_xor_b32 v5, 96, v63
    v_add_u32 v134, v59, v5
    v_xor_b32 v5, 128, v5
    v_add_u32 v135, v59, v5
    v_xor_b32 v5, 128, v63
    v_add_u32 v136, v59, v5
    v_xor_b32 v5, 128, v5
    v_add_u32 v137, v59, v5
    v_xor_b32 v5, 160, v63
    v_add_u32 v138, v59, v5
    v_xor_b32 v5, 128, v5
    v_add_u32 v139, v59, v5
    v_xor_b32 v5, 192, v63
    v_add_u32 v140, v59, v5
    v_xor_b32 v5, 128, v5
    v_add_u32 v141, v59, v5
    v_xor_b32 v5, 224, v63
    v_add_u32 v142, v59, v5
    v_xor_b32 v5, 128, v5
    v_add_u32 v143, v59, v5
    s_waitcnt lgkmcnt(0)
    ds_read_b64_tr_b16 v[64:65], v128
    ds_read_b64_tr_b16 v[66:67], v129 offset:1024
    ds_read_b64_tr_b16 v[68:69], v132
    ds_read_b64_tr_b16 v[70:71], v133 offset:1024
    ds_read_b64_tr_b16 v[72:73], v136
    ds_read_b64_tr_b16 v[74:75], v137 offset:1024
    ds_read_b64_tr_b16 v[76:77], v140
    ds_read_b64_tr_b16 v[78:79], v141 offset:1024
    s_waitcnt lgkmcnt(6)
    s_add_u32 s46, s42, 0
    buffer_store_dwordx4 v[64:67], v7, s[20:23], s46 offen sc1
    s_waitcnt lgkmcnt(4)
    s_add_u32 s46, s42, 65536
    buffer_store_dwordx4 v[68:71], v7, s[20:23], s46 offen sc1
    s_waitcnt lgkmcnt(2)
    s_add_u32 s46, s42, 131072
    buffer_store_dwordx4 v[72:75], v7, s[20:23], s46 offen sc1
    s_waitcnt lgkmcnt(0)
    s_add_u32 s46, s42, 196608
    buffer_store_dwordx4 v[76:79], v7, s[20:23], s46 offen sc1
    v_fma_f32 v80, v144, v50, v80
    v_fma_f32 v112, v144, v51, v112
    v_fma_f32 v80, -v176, v51, v80
    v_fma_f32 v112, v176, v50, v112
    v_fma_f32 v81, v145, v50, v81
    v_fma_f32 v113, v145, v51, v113
    v_fma_f32 v81, -v177, v51, v81
    v_fma_f32 v113, v177, v50, v113
    v_cvt_pk_bf16_f32 v224, v80, v81
    v_cvt_pk_bf16_f32 v240, -v112, -v113
    v_fma_f32 v82, v146, v50, v82
    v_fma_f32 v114, v146, v51, v114
    v_fma_f32 v82, -v178, v51, v82
    v_fma_f32 v114, v178, v50, v114
    v_fma_f32 v83, v147, v50, v83
    v_fma_f32 v115, v147, v51, v115
    v_fma_f32 v83, -v179, v51, v83
    v_fma_f32 v115, v179, v50, v115
    v_cvt_pk_bf16_f32 v225, v82, v83
    v_cvt_pk_bf16_f32 v241, -v114, -v115
    v_fma_f32 v84, v148, v50, v84
    v_fma_f32 v116, v148, v51, v116
    v_fma_f32 v84, -v180, v51, v84
    v_fma_f32 v116, v180, v50, v116
    v_fma_f32 v85, v149, v50, v85
    v_fma_f32 v117, v149, v51, v117
    v_fma_f32 v85, -v181, v51, v85
    v_fma_f32 v117, v181, v50, v117
    v_cvt_pk_bf16_f32 v226, v84, v85
    v_cvt_pk_bf16_f32 v242, -v116, -v117
    v_fma_f32 v86, v150, v50, v86
    v_fma_f32 v118, v150, v51, v118
    v_fma_f32 v86, -v182, v51, v86
    v_fma_f32 v118, v182, v50, v118
    v_fma_f32 v87, v151, v50, v87
    v_fma_f32 v119, v151, v51, v119
    v_fma_f32 v87, -v183, v51, v87
    v_fma_f32 v119, v183, v50, v119
    v_cvt_pk_bf16_f32 v227, v86, v87
    v_cvt_pk_bf16_f32 v243, -v118, -v119
    v_fma_f32 v88, v152, v50, v88
    v_fma_f32 v120, v152, v51, v120
    v_fma_f32 v88, -v184, v51, v88
    v_fma_f32 v120, v184, v50, v120
    v_fma_f32 v89, v153, v50, v89
    v_fma_f32 v121, v153, v51, v121
    v_fma_f32 v89, -v185, v51, v89
    v_fma_f32 v121, v185, v50, v121
    v_cvt_pk_bf16_f32 v228, v88, v89
    v_cvt_pk_bf16_f32 v244, -v120, -v121
    v_fma_f32 v90, v154, v50, v90
    v_fma_f32 v122, v154, v51, v122
    v_fma_f32 v90, -v186, v51, v90
    v_fma_f32 v122, v186, v50, v122
    v_fma_f32 v91, v155, v50, v91
    v_fma_f32 v123, v155, v51, v123
    v_fma_f32 v91, -v187, v51, v91
    v_fma_f32 v123, v187, v50, v123
    v_cvt_pk_bf16_f32 v229, v90, v91
    v_cvt_pk_bf16_f32 v245, -v122, -v123
    v_fma_f32 v92, v156, v50, v92
    v_fma_f32 v124, v156, v51, v124
    v_fma_f32 v92, -v188, v51, v92
    v_fma_f32 v124, v188, v50, v124
    v_fma_f32 v93, v157, v50, v93
    v_fma_f32 v125, v157, v51, v125
    v_fma_f32 v93, -v189, v51, v93
    v_fma_f32 v125, v189, v50, v125
    v_cvt_pk_bf16_f32 v230, v92, v93
    v_cvt_pk_bf16_f32 v246, -v124, -v125
    v_fma_f32 v94, v158, v50, v94
    v_fma_f32 v126, v158, v51, v126
    v_fma_f32 v94, -v190, v51, v94
    v_fma_f32 v126, v190, v50, v126
    v_fma_f32 v95, v159, v50, v95
    v_fma_f32 v127, v159, v51, v127
    v_fma_f32 v95, -v191, v51, v95
    v_fma_f32 v127, v191, v50, v127
    v_cvt_pk_bf16_f32 v231, v94, v95
    v_cvt_pk_bf16_f32 v247, -v126, -v127
    ds_write_b128 v58, v[224:227] offset:0
    ds_write_b128 v58, v[228:231] offset:16
    ds_write_b128 v58, v[240:243] offset:4096
    ds_write_b128 v58, v[244:247] offset:4112
    s_waitcnt lgkmcnt(0)
    ds_read_b64_tr_b16 v[80:81], v130
    ds_read_b64_tr_b16 v[82:83], v131 offset:1024
    ds_read_b64_tr_b16 v[84:85], v134
    ds_read_b64_tr_b16 v[86:87], v135 offset:1024
    ds_read_b64_tr_b16 v[88:89], v138
    ds_read_b64_tr_b16 v[90:91], v139 offset:1024
    ds_read_b64_tr_b16 v[92:93], v142
    ds_read_b64_tr_b16 v[94:95], v143 offset:1024
    s_waitcnt lgkmcnt(6)
    s_add_u32 s46, s42, 32768
    buffer_store_dwordx4 v[80:83], v7, s[20:23], s46 offen sc1
    s_waitcnt lgkmcnt(4)
    s_add_u32 s46, s42, 98304
    buffer_store_dwordx4 v[84:87], v7, s[20:23], s46 offen sc1
    s_waitcnt lgkmcnt(2)
    s_add_u32 s46, s42, 163840
    buffer_store_dwordx4 v[88:91], v7, s[20:23], s46 offen sc1
    s_waitcnt lgkmcnt(0)
    s_add_u32 s46, s42, 229376
    buffer_store_dwordx4 v[92:95], v7, s[20:23], s46 offen sc1
    s_mov_b32 s26, s40
    s_mov_b32 s27, s41
    s_mov_b32 s31, 1
    s_and_b32 s28, s6, 3
    s_lshl_b32 s28, s28, 3
    s_and_b32 s42, s7, 7
    s_or_b32 s28, s28, s42
    s_lshr_b32 s29, s7, 3
    s_and_b32 s30, s3, 3
    s_mov_b32 s36, s76
    s_and_b32 s37, s77, 0xffff
    s_mov_b32 s38, 0x800000
    s_mov_b32 s39, 0x00020000
    v_lshrrev_b32 v3, 4, v2
    v_and_b32 v4, 15, v2
    v_lshlrev_b32 v10, 4, v2
    s_lshl_b32 s42, s28, 6
    s_lshl_b32 s43, s31, 4
    s_add_u32 s42, s42, s43
    v_add_u32 v5, s42, v4
    s_lshl_b32 s42, s29, 7
    s_lshl_b32 s43, s30, 5
    s_add_u32 s42, s42, s43
    v_lshl_add_u32 v7, v3, 2, s42
    v_lshlrev_b32 v6, 10, v5
    v_add_u32 v6, v6, v7
    v_lshlrev_b32 v6, 2, v6
    s_lshl_b32 s42, s31, 2
    s_add_u32 s42, s42, s30
    s_lshl_b32 s42, s42, 12
    v_add_u32 v12, s42, v10
    s_xor_b32 s42, s42, 0x4000
    v_add_u32 v11, s42, v10
    v_lshrrev_b32 v8, 1, v3
    v_lshlrev_b32 v8, 10, v8
    v_and_b32 v9, 31, v2
    v_lshl_add_u32 v8, v9, 4, v8
    s_lshl_b32 s42, s31, 16
    s_add_u32 s42, s42, 32768
    v_add_u32 v8, s42, v8
    v_lshlrev_b32 v13, 9, v5
    v_add_u32 v13, v13, v7
    v_lshlrev_b32 v13, 1, v13
    v_add_u32 v14, 0x8000, v13
    v_lshlrev_b32 v15, 1, v7
    global_load_dwordx2 v[96:97], v13, s[24:25] offset:0
    global_load_dwordx2 v[98:99], v13, s[24:25] offset:32
    global_load_dwordx2 v[100:101], v14, s[24:25] offset:0
    global_load_dwordx2 v[102:103], v14, s[24:25] offset:32
    global_load_dwordx2 v[104:105], v15, s[74:75] offset:0
    global_load_dwordx2 v[106:107], v15, s[74:75] offset:32
    s_lshl_b32 s42, s3, 15
    s_add_u32 s42, s42, 32768
    v_lshrrev_b32 v34, 1, v4
    v_xor_b32 v34, v34, v3
    v_lshlrev_b32 v35, 7, v4
    v_lshl_add_u32 v34, v34, 4, v35
    v_add_u32 v34, s42, v34
    v_xor_b32 v35, 64, v34
    s_lshl_b32 s42, s4, 2
    s_lshr_b32 s43, s5, 1
    s_add_u32 s42, s42, s43
    s_mul_i32 s42, s42, 4352
    s_and_b32 s43, s5, 1
    s_lshl_b32 s43, s43, 2
    s_add_u32 s43, s43, s3
    s_lshl_b32 s43, s43, 3
    s_add_u32 s42, s42, s43
    s_add_u32 s42, s42, 0x40000
    v_mov_b32 v0, s40
    v_mov_b32 v1, s41
    v_mov_b32 v21, 0
    s_waitcnt vmcnt(6)
    s_mov_b64 exec, 1
    buffer_store_dwordx2 v[0:1], v21, s[20:23], s42 offen sc1
    s_mov_b64 exec, -1
    s_barrier
    ds_read_b128 v[128:131], v34 offset:0
    ds_read_b128 v[132:135], v34 offset:2048
    ds_read_b128 v[136:139], v34 offset:4096
    ds_read_b128 v[140:143], v34 offset:6144
    ds_read_b128 v[144:147], v35 offset:0
    ds_read_b128 v[148:151], v35 offset:2048
    ds_read_b128 v[152:155], v35 offset:4096
    ds_read_b128 v[156:159], v35 offset:6144
    ds_read_b128 v[160:163], v34 offset:8192
    ds_read_b128 v[164:167], v34 offset:10240
    ds_read_b128 v[168:171], v34 offset:12288
    ds_read_b128 v[172:175], v34 offset:14336
    ds_read_b128 v[176:179], v35 offset:8192
    ds_read_b128 v[180:183], v35 offset:10240
    ds_read_b128 v[184:187], v35 offset:12288
    ds_read_b128 v[188:191], v35 offset:14336
    ds_read_b128 v[192:195], v34 offset:16384
    ds_read_b128 v[196:199], v34 offset:18432
    ds_read_b128 v[200:203], v34 offset:20480
    ds_read_b128 v[204:207], v34 offset:22528
    ds_read_b128 v[208:211], v35 offset:16384
    ds_read_b128 v[212:215], v35 offset:18432
    ds_read_b128 v[216:219], v35 offset:20480
    ds_read_b128 v[220:223], v35 offset:22528
    ds_read_b128 v[224:227], v34 offset:24576
    ds_read_b128 v[228:231], v34 offset:26624
    ds_read_b128 v[232:235], v34 offset:28672
    ds_read_b128 v[236:239], v34 offset:30720
    ds_read_b128 v[240:243], v35 offset:24576
    ds_read_b128 v[244:247], v35 offset:26624
    ds_read_b128 v[248:251], v35 offset:28672
    ds_read_b128 v[252:255], v35 offset:30720
    s_waitcnt vmcnt(1)
    v_lshlrev_b32 v108, 16, v104
    v_and_b32 v109, 0xffff0000, v104
    v_lshlrev_b32 v110, 16, v105
    v_and_b32 v111, 0xffff0000, v105
    v_lshlrev_b32 v16, 16, v96
    v_and_b32 v17, 0xffff0000, v96
    v_lshlrev_b32 v18, 16, v97
    v_and_b32 v19, 0xffff0000, v97
    v_mul_f32 v16, v16, v108
    v_mul_f32 v17, v17, v109
    v_mul_f32 v18, v18, v110
    v_mul_f32 v19, v19, v111
    v_cvt_pk_bf16_f32 v112, v16, v17
    v_lshlrev_b32 v16, 16, v112
    v_and_b32 v17, 0xffff0000, v112
    v_cvt_pk_bf16_f32 v112, v18, v19
    v_lshlrev_b32 v18, 16, v112
    v_and_b32 v19, 0xffff0000, v112
    v_lshlrev_b32 v24, 16, v100
    v_and_b32 v25, 0xffff0000, v100
    v_lshlrev_b32 v26, 16, v101
    v_and_b32 v27, 0xffff0000, v101
    v_mul_f32 v24, v24, v108
    v_mul_f32 v25, v25, v109
    v_mul_f32 v26, v26, v110
    v_mul_f32 v27, v27, v111
    v_cvt_pk_bf16_f32 v112, v24, v25
    v_lshlrev_b32 v24, 16, v112
    v_and_b32 v25, 0xffff0000, v112
    v_cvt_pk_bf16_f32 v112, v26, v27
    v_lshlrev_b32 v26, 16, v112
    v_and_b32 v27, 0xffff0000, v112
    v_lshlrev_b32 v108, 16, v106
    v_and_b32 v109, 0xffff0000, v106
    v_lshlrev_b32 v110, 16, v107
    v_and_b32 v111, 0xffff0000, v107
    v_lshlrev_b32 v20, 16, v98
    v_and_b32 v21, 0xffff0000, v98
    v_lshlrev_b32 v22, 16, v99
    v_and_b32 v23, 0xffff0000, v99
    v_mul_f32 v20, v20, v108
    v_mul_f32 v21, v21, v109
    v_mul_f32 v22, v22, v110
    v_mul_f32 v23, v23, v111
    v_cvt_pk_bf16_f32 v112, v20, v21
    v_lshlrev_b32 v20, 16, v112
    v_and_b32 v21, 0xffff0000, v112
    v_cvt_pk_bf16_f32 v112, v22, v23
    v_lshlrev_b32 v22, 16, v112
    v_and_b32 v23, 0xffff0000, v112
    v_lshlrev_b32 v28, 16, v102
    v_and_b32 v29, 0xffff0000, v102
    v_lshlrev_b32 v30, 16, v103
    v_and_b32 v31, 0xffff0000, v103
    v_mul_f32 v28, v28, v108
    v_mul_f32 v29, v29, v109
    v_mul_f32 v30, v30, v110
    v_mul_f32 v31, v31, v111
    v_cvt_pk_bf16_f32 v112, v28, v29
    v_lshlrev_b32 v28, 16, v112
    v_and_b32 v29, 0xffff0000, v112
    v_cvt_pk_bf16_f32 v112, v30, v31
    v_lshlrev_b32 v30, 16, v112
    v_and_b32 v31, 0xffff0000, v112
    s_waitcnt lgkmcnt(0)
    s_barrier
    v_add_u32 v5, 0x20000, v6
    s_barrier
    ds_read_b128 v[64:67], v8 offset:0
    ds_read_b128 v[68:71], v8 offset:512
    ds_read_b128 v[72:75], v8 offset:2048
    ds_read_b128 v[76:79], v8 offset:2560
    ds_read_b128 v[80:83], v8 offset:4096
    ds_read_b128 v[84:87], v8 offset:4608
    ds_read_b128 v[88:91], v8 offset:6144
    ds_read_b128 v[92:95], v8 offset:6656
    ds_read_b128 v[96:99], v8 offset:32768
    s_waitcnt lgkmcnt(8)
    v_mfma_f32_16x16x32_bf16 v[32:35], v[128:131], v[64:67], 0
    v_mfma_f32_16x16x32_bf16 v[36:39], v[132:135], v[64:67], 0
    ds_read_b128 v[100:103], v8 offset:33280
    s_waitcnt lgkmcnt(8)
    v_mfma_f32_16x16x32_bf16 v[32:35], v[136:139], v[68:71], v[32:35]
    v_mfma_f32_16x16x32_bf16 v[36:39], v[140:143], v[68:71], v[36:39]
    ds_read_b128 v[104:107], v8 offset:34816
    s_waitcnt lgkmcnt(8)
    v_mfma_f32_16x16x32_bf16 v[32:35], v[144:147], v[72:75], v[32:35]
    v_mfma_f32_16x16x32_bf16 v[36:39], v[148:151], v[72:75], v[36:39]
    ds_read_b128 v[108:111], v8 offset:35328
    s_waitcnt lgkmcnt(8)
    v_mfma_f32_16x16x32_bf16 v[32:35], v[152:155], v[76:79], v[32:35]
    v_mfma_f32_16x16x32_bf16 v[36:39], v[156:159], v[76:79], v[36:39]
    ds_read_b128 v[64:67], v8 offset:36864
    s_waitcnt lgkmcnt(8)
    v_mfma_f32_16x16x32_bf16 v[32:35], v[160:163], v[80:83], v[32:35]
    v_mfma_f32_16x16x32_bf16 v[36:39], v[164:167], v[80:83], v[36:39]
    ds_read_b128 v[68:71], v8 offset:37376
    s_waitcnt lgkmcnt(8)
    v_mfma_f32_16x16x32_bf16 v[32:35], v[168:171], v[84:87], v[32:35]
    v_mfma_f32_16x16x32_bf16 v[36:39], v[172:175], v[84:87], v[36:39]
    ds_read_b128 v[72:75], v8 offset:38912
    s_waitcnt lgkmcnt(8)
    v_mfma_f32_16x16x32_bf16 v[32:35], v[176:179], v[88:91], v[32:35]
    v_mfma_f32_16x16x32_bf16 v[36:39], v[180:183], v[88:91], v[36:39]
    ds_read_b128 v[76:79], v8 offset:39424
    s_waitcnt lgkmcnt(8)
    v_mfma_f32_16x16x32_bf16 v[32:35], v[184:187], v[92:95], v[32:35]
    v_mfma_f32_16x16x32_bf16 v[36:39], v[188:191], v[92:95], v[36:39]
    s_barrier
    ds_read_b128 v[80:83], v8 offset:8192
    s_waitcnt lgkmcnt(8)
    v_mfma_f32_16x16x32_bf16 v[32:35], v[192:195], v[96:99], v[32:35]
    v_mfma_f32_16x16x32_bf16 v[36:39], v[196:199], v[96:99], v[36:39]
    ds_read_b128 v[84:87], v8 offset:8704
    s_waitcnt lgkmcnt(8)
    v_mfma_f32_16x16x32_bf16 v[32:35], v[200:203], v[100:103], v[32:35]
    v_mfma_f32_16x16x32_bf16 v[36:39], v[204:207], v[100:103], v[36:39]
    ds_read_b128 v[88:91], v8 offset:10240
    s_waitcnt lgkmcnt(8)
    v_mfma_f32_16x16x32_bf16 v[32:35], v[208:211], v[104:107], v[32:35]
    v_mfma_f32_16x16x32_bf16 v[36:39], v[212:215], v[104:107], v[36:39]
    ds_read_b128 v[92:95], v8 offset:10752
    s_waitcnt lgkmcnt(8)
    v_mfma_f32_16x16x32_bf16 v[32:35], v[216:219], v[108:111], v[32:35]
    v_mfma_f32_16x16x32_bf16 v[36:39], v[220:223], v[108:111], v[36:39]
    ds_read_b128 v[96:99], v8 offset:12288
    s_waitcnt lgkmcnt(8)
    v_mfma_f32_16x16x32_bf16 v[32:35], v[224:227], v[64:67], v[32:35]
    v_mfma_f32_16x16x32_bf16 v[36:39], v[228:231], v[64:67], v[36:39]
    ds_read_b128 v[100:103], v8 offset:12800
    s_waitcnt lgkmcnt(8)
    v_mfma_f32_16x16x32_bf16 v[32:35], v[232:235], v[68:71], v[32:35]
    v_mfma_f32_16x16x32_bf16 v[36:39], v[236:239], v[68:71], v[36:39]
    ds_read_b128 v[104:107], v8 offset:14336
    s_waitcnt lgkmcnt(8)
    v_mfma_f32_16x16x32_bf16 v[32:35], v[240:243], v[72:75], v[32:35]
    v_mfma_f32_16x16x32_bf16 v[36:39], v[244:247], v[72:75], v[36:39]
    ds_read_b128 v[108:111], v8 offset:14848
    s_waitcnt lgkmcnt(8)
    v_mfma_f32_16x16x32_bf16 v[32:35], v[248:251], v[76:79], v[32:35]
    v_mfma_f32_16x16x32_bf16 v[36:39], v[252:255], v[76:79], v[36:39]
    s_nop 9
    ds_write_b128 v11, v[32:35] offset:0
    ds_write_b128 v11, v[36:39] offset:1024
    ds_read_b128 v[64:67], v8 offset:40960
    s_waitcnt lgkmcnt(10)
    v_mfma_f32_16x16x32_bf16 v[40:43], v[128:131], v[80:83], 0
    v_mfma_f32_16x16x32_bf16 v[44:47], v[132:135], v[80:83], 0
    ds_read_b128 v[68:71], v8 offset:41472
    s_waitcnt lgkmcnt(10)
    v_mfma_f32_16x16x32_bf16 v[40:43], v[136:139], v[84:87], v[40:43]
    v_mfma_f32_16x16x32_bf16 v[44:47], v[140:143], v[84:87], v[44:47]
    ds_read_b128 v[72:75], v8 offset:43008
    s_waitcnt lgkmcnt(10)
    v_mfma_f32_16x16x32_bf16 v[40:43], v[144:147], v[88:91], v[40:43]
    v_mfma_f32_16x16x32_bf16 v[44:47], v[148:151], v[88:91], v[44:47]
    ds_read_b128 v[76:79], v8 offset:43520
    s_waitcnt lgkmcnt(10)
    v_mfma_f32_16x16x32_bf16 v[40:43], v[152:155], v[92:95], v[40:43]
    v_mfma_f32_16x16x32_bf16 v[44:47], v[156:159], v[92:95], v[44:47]
    ds_read_b128 v[80:83], v8 offset:45056
    s_waitcnt lgkmcnt(10)
    v_mfma_f32_16x16x32_bf16 v[40:43], v[160:163], v[96:99], v[40:43]
    v_mfma_f32_16x16x32_bf16 v[44:47], v[164:167], v[96:99], v[44:47]
    ds_read_b128 v[84:87], v8 offset:45568
    s_waitcnt lgkmcnt(10)
    v_mfma_f32_16x16x32_bf16 v[40:43], v[168:171], v[100:103], v[40:43]
    v_mfma_f32_16x16x32_bf16 v[44:47], v[172:175], v[100:103], v[44:47]
    ds_read_b128 v[88:91], v8 offset:47104
    s_waitcnt lgkmcnt(10)
    v_mfma_f32_16x16x32_bf16 v[40:43], v[176:179], v[104:107], v[40:43]
    v_mfma_f32_16x16x32_bf16 v[44:47], v[180:183], v[104:107], v[44:47]
    ds_read_b128 v[92:95], v8 offset:47616
    s_waitcnt lgkmcnt(10)
    v_mfma_f32_16x16x32_bf16 v[40:43], v[184:187], v[108:111], v[40:43]
    v_mfma_f32_16x16x32_bf16 v[44:47], v[188:191], v[108:111], v[44:47]
    s_waitcnt lgkmcnt(8)
    s_barrier
    ds_read_b128 v[96:99], v8 offset:16384
    s_waitcnt lgkmcnt(8)
    v_mfma_f32_16x16x32_bf16 v[40:43], v[192:195], v[64:67], v[40:43]
    v_mfma_f32_16x16x32_bf16 v[44:47], v[196:199], v[64:67], v[44:47]
    ds_read_b128 v[100:103], v8 offset:16896
    s_waitcnt lgkmcnt(8)
    v_mfma_f32_16x16x32_bf16 v[40:43], v[200:203], v[68:71], v[40:43]
    v_mfma_f32_16x16x32_bf16 v[44:47], v[204:207], v[68:71], v[44:47]
    ds_read_b128 v[104:107], v8 offset:18432
    s_waitcnt lgkmcnt(8)
    v_mfma_f32_16x16x32_bf16 v[40:43], v[208:211], v[72:75], v[40:43]
    v_mfma_f32_16x16x32_bf16 v[44:47], v[212:215], v[72:75], v[44:47]
    ds_read_b128 v[108:111], v8 offset:18944
    s_waitcnt lgkmcnt(8)
    v_mfma_f32_16x16x32_bf16 v[40:43], v[216:219], v[76:79], v[40:43]
    v_mfma_f32_16x16x32_bf16 v[44:47], v[220:223], v[76:79], v[44:47]
    ds_read_b128 v[64:67], v8 offset:20480
    s_waitcnt lgkmcnt(8)
    v_mfma_f32_16x16x32_bf16 v[40:43], v[224:227], v[80:83], v[40:43]
    v_mfma_f32_16x16x32_bf16 v[44:47], v[228:231], v[80:83], v[44:47]
    ds_read_b128 v[68:71], v8 offset:20992
    s_waitcnt lgkmcnt(8)
    v_mfma_f32_16x16x32_bf16 v[40:43], v[232:235], v[84:87], v[40:43]
    v_mfma_f32_16x16x32_bf16 v[44:47], v[236:239], v[84:87], v[44:47]
    ds_read_b128 v[72:75], v8 offset:22528
    s_waitcnt lgkmcnt(8)
    v_mfma_f32_16x16x32_bf16 v[40:43], v[240:243], v[88:91], v[40:43]
    v_mfma_f32_16x16x32_bf16 v[44:47], v[244:247], v[88:91], v[44:47]
    ds_read_b128 v[76:79], v8 offset:23040
    s_waitcnt lgkmcnt(8)
    v_mfma_f32_16x16x32_bf16 v[40:43], v[248:251], v[92:95], v[40:43]
    v_mfma_f32_16x16x32_bf16 v[44:47], v[252:255], v[92:95], v[44:47]
    ds_read_b128 v[80:83], v8 offset:49152
    s_waitcnt lgkmcnt(8)
    v_mfma_f32_16x16x32_bf16 v[32:35], v[128:131], v[96:99], 0
    v_mfma_f32_16x16x32_bf16 v[36:39], v[132:135], v[96:99], 0
    ds_read_b128 v[84:87], v8 offset:49664
    s_waitcnt lgkmcnt(8)
    v_mfma_f32_16x16x32_bf16 v[32:35], v[136:139], v[100:103], v[32:35]
    v_mfma_f32_16x16x32_bf16 v[36:39], v[140:143], v[100:103], v[36:39]
    ds_read_b128 v[88:91], v8 offset:51200
    s_waitcnt lgkmcnt(8)
    v_mfma_f32_16x16x32_bf16 v[32:35], v[144:147], v[104:107], v[32:35]
    v_mfma_f32_16x16x32_bf16 v[36:39], v[148:151], v[104:107], v[36:39]
    ds_read_b128 v[92:95], v8 offset:51712
    s_waitcnt lgkmcnt(8)
    v_mfma_f32_16x16x32_bf16 v[32:35], v[152:155], v[108:111], v[32:35]
    v_mfma_f32_16x16x32_bf16 v[36:39], v[156:159], v[108:111], v[36:39]
    ds_read_b128 v[96:99], v8 offset:53248
    s_waitcnt lgkmcnt(8)
    v_mfma_f32_16x16x32_bf16 v[32:35], v[160:163], v[64:67], v[32:35]
    v_mfma_f32_16x16x32_bf16 v[36:39], v[164:167], v[64:67], v[36:39]
    ds_read_b128 v[100:103], v8 offset:53760
    s_waitcnt lgkmcnt(8)
    v_mfma_f32_16x16x32_bf16 v[32:35], v[168:171], v[68:71], v[32:35]
    v_mfma_f32_16x16x32_bf16 v[36:39], v[172:175], v[68:71], v[36:39]
    ds_read_b128 v[104:107], v8 offset:55296
    s_waitcnt lgkmcnt(8)
    v_mfma_f32_16x16x32_bf16 v[32:35], v[176:179], v[72:75], v[32:35]
    v_mfma_f32_16x16x32_bf16 v[36:39], v[180:183], v[72:75], v[36:39]
    ds_read_b128 v[108:111], v8 offset:55808
    s_waitcnt lgkmcnt(8)
    v_mfma_f32_16x16x32_bf16 v[32:35], v[184:187], v[76:79], v[32:35]
    v_mfma_f32_16x16x32_bf16 v[36:39], v[188:191], v[76:79], v[36:39]
    s_barrier
    ds_read_b128 v[112:115], v12 offset:0
    ds_read_b128 v[116:119], v12 offset:1024
    ds_read_b128 v[64:67], v8 offset:24576
    s_waitcnt lgkmcnt(10)
    v_mfma_f32_16x16x32_bf16 v[32:35], v[192:195], v[80:83], v[32:35]
    v_mfma_f32_16x16x32_bf16 v[36:39], v[196:199], v[80:83], v[36:39]
    ds_read_b128 v[68:71], v8 offset:25088
    s_waitcnt lgkmcnt(10)
    v_mfma_f32_16x16x32_bf16 v[32:35], v[200:203], v[84:87], v[32:35]
    v_mfma_f32_16x16x32_bf16 v[36:39], v[204:207], v[84:87], v[36:39]
    ds_read_b128 v[72:75], v8 offset:26624
    s_waitcnt lgkmcnt(10)
    v_mfma_f32_16x16x32_bf16 v[32:35], v[208:211], v[88:91], v[32:35]
    v_mfma_f32_16x16x32_bf16 v[36:39], v[212:215], v[88:91], v[36:39]
    s_waitcnt lgkmcnt(4)
    v_add_f32 v112, v112, v40
    v_add_f32 v113, v113, v41
    v_add_f32 v114, v114, v42
    v_add_f32 v115, v115, v43
    v_fma_f32 v112, 2.0, v112, v16
    v_fma_f32 v113, 2.0, v113, v17
    v_fma_f32 v114, 2.0, v114, v18
    v_fma_f32 v115, 2.0, v115, v19
    buffer_store_dwordx4 v[112:115], v6, s[36:39], 0 offen offset:0 sc1
    s_waitcnt lgkmcnt(3)
    v_add_f32 v116, v116, v44
    v_add_f32 v117, v117, v45
    v_add_f32 v118, v118, v46
    v_add_f32 v119, v119, v47
    v_fma_f32 v116, 2.0, v116, v20
    v_fma_f32 v117, 2.0, v117, v21
    v_fma_f32 v118, 2.0, v118, v22
    v_fma_f32 v119, 2.0, v119, v23
    buffer_store_dwordx4 v[116:119], v6, s[36:39], 0 offen offset:64 sc1
    ds_read_b128 v[76:79], v8 offset:27136
    s_waitcnt lgkmcnt(10)
    v_mfma_f32_16x16x32_bf16 v[32:35], v[216:219], v[92:95], v[32:35]
    v_mfma_f32_16x16x32_bf16 v[36:39], v[220:223], v[92:95], v[36:39]
    ds_read_b128 v[80:83], v8 offset:28672
    s_waitcnt lgkmcnt(10)
    v_mfma_f32_16x16x32_bf16 v[32:35], v[224:227], v[96:99], v[32:35]
    v_mfma_f32_16x16x32_bf16 v[36:39], v[228:231], v[96:99], v[36:39]
    ds_read_b128 v[84:87], v8 offset:29184
    s_waitcnt lgkmcnt(10)
    v_mfma_f32_16x16x32_bf16 v[32:35], v[232:235], v[100:103], v[32:35]
    v_mfma_f32_16x16x32_bf16 v[36:39], v[236:239], v[100:103], v[36:39]
    ds_read_b128 v[88:91], v8 offset:30720
    s_waitcnt lgkmcnt(10)
    v_mfma_f32_16x16x32_bf16 v[32:35], v[240:243], v[104:107], v[32:35]
    v_mfma_f32_16x16x32_bf16 v[36:39], v[244:247], v[104:107], v[36:39]
    ds_read_b128 v[92:95], v8 offset:31232
    s_waitcnt lgkmcnt(10)
    v_mfma_f32_16x16x32_bf16 v[32:35], v[248:251], v[108:111], v[32:35]
    v_mfma_f32_16x16x32_bf16 v[36:39], v[252:255], v[108:111], v[36:39]
    s_nop 9
    ds_write_b128 v11, v[32:35] offset:2048
    ds_write_b128 v11, v[36:39] offset:3072
    ds_read_b128 v[96:99], v8 offset:57344
    s_waitcnt lgkmcnt(10)
    v_mfma_f32_16x16x32_bf16 v[40:43], v[128:131], v[64:67], 0
    v_mfma_f32_16x16x32_bf16 v[44:47], v[132:135], v[64:67], 0
    s_waitcnt lgkmcnt(1)
    s_barrier
    ds_read_b128 v[100:103], v8 offset:57856
    s_waitcnt lgkmcnt(10)
    v_mfma_f32_16x16x32_bf16 v[40:43], v[136:139], v[68:71], v[40:43]
    v_mfma_f32_16x16x32_bf16 v[44:47], v[140:143], v[68:71], v[44:47]
    ds_read_b128 v[104:107], v8 offset:59392
    s_waitcnt lgkmcnt(10)
    v_mfma_f32_16x16x32_bf16 v[40:43], v[144:147], v[72:75], v[40:43]
    v_mfma_f32_16x16x32_bf16 v[44:47], v[148:151], v[72:75], v[44:47]
    ds_read_b128 v[108:111], v8 offset:59904
    s_waitcnt lgkmcnt(10)
    v_mfma_f32_16x16x32_bf16 v[40:43], v[152:155], v[76:79], v[40:43]
    v_mfma_f32_16x16x32_bf16 v[44:47], v[156:159], v[76:79], v[44:47]
    ds_read_b128 v[64:67], v8 offset:61440
    s_waitcnt lgkmcnt(10)
    v_mfma_f32_16x16x32_bf16 v[40:43], v[160:163], v[80:83], v[40:43]
    v_mfma_f32_16x16x32_bf16 v[44:47], v[164:167], v[80:83], v[44:47]
    ds_read_b128 v[68:71], v8 offset:61952
    s_waitcnt lgkmcnt(10)
    v_mfma_f32_16x16x32_bf16 v[40:43], v[168:171], v[84:87], v[40:43]
    v_mfma_f32_16x16x32_bf16 v[44:47], v[172:175], v[84:87], v[44:47]
    ds_read_b128 v[72:75], v8 offset:63488
    s_waitcnt lgkmcnt(10)
    v_mfma_f32_16x16x32_bf16 v[40:43], v[176:179], v[88:91], v[40:43]
    v_mfma_f32_16x16x32_bf16 v[44:47], v[180:183], v[88:91], v[44:47]
    ds_read_b128 v[76:79], v8 offset:64000
    s_waitcnt lgkmcnt(10)
    v_mfma_f32_16x16x32_bf16 v[40:43], v[184:187], v[92:95], v[40:43]
    v_mfma_f32_16x16x32_bf16 v[44:47], v[188:191], v[92:95], v[44:47]
    s_waitcnt lgkmcnt(7)
    v_mfma_f32_16x16x32_bf16 v[40:43], v[192:195], v[96:99], v[40:43]
    v_mfma_f32_16x16x32_bf16 v[44:47], v[196:199], v[96:99], v[44:47]
    s_waitcnt lgkmcnt(6)
    v_mfma_f32_16x16x32_bf16 v[40:43], v[200:203], v[100:103], v[40:43]
    v_mfma_f32_16x16x32_bf16 v[44:47], v[204:207], v[100:103], v[44:47]
    s_barrier
    ds_read_b128 v[112:115], v12 offset:2048
    ds_read_b128 v[116:119], v12 offset:3072
    s_waitcnt lgkmcnt(7)
    v_mfma_f32_16x16x32_bf16 v[40:43], v[208:211], v[104:107], v[40:43]
    s_waitcnt lgkmcnt(6)
    v_mfma_f32_16x16x32_bf16 v[40:43], v[216:219], v[108:111], v[40:43]
    s_waitcnt lgkmcnt(5)
    v_mfma_f32_16x16x32_bf16 v[40:43], v[224:227], v[64:67], v[40:43]
    s_waitcnt lgkmcnt(4)
    v_mfma_f32_16x16x32_bf16 v[40:43], v[232:235], v[68:71], v[40:43]
    s_waitcnt lgkmcnt(3)
    v_mfma_f32_16x16x32_bf16 v[40:43], v[240:243], v[72:75], v[40:43]
    s_waitcnt lgkmcnt(2)
    v_mfma_f32_16x16x32_bf16 v[40:43], v[248:251], v[76:79], v[40:43]
    v_mfma_f32_16x16x32_bf16 v[44:47], v[212:215], v[104:107], v[44:47]
    s_waitcnt lgkmcnt(0)
    v_fma_f32 v112, 2.0, v112, v24
    v_fma_f32 v113, 2.0, v113, v25
    v_fma_f32 v114, 2.0, v114, v26
    v_fma_f32 v115, 2.0, v115, v27
    v_mfma_f32_16x16x32_bf16 v[44:47], v[220:223], v[108:111], v[44:47]
    v_fma_f32 v116, 2.0, v116, v28
    v_fma_f32 v117, 2.0, v117, v29
    v_fma_f32 v118, 2.0, v118, v30
    v_fma_f32 v119, 2.0, v119, v31
    v_mfma_f32_16x16x32_bf16 v[44:47], v[228:231], v[64:67], v[44:47]
    v_fma_f32 v112, 2.0, v40, v112
    v_fma_f32 v113, 2.0, v41, v113
    v_fma_f32 v114, 2.0, v42, v114
    v_fma_f32 v115, 2.0, v43, v115
    v_mfma_f32_16x16x32_bf16 v[44:47], v[236:239], v[68:71], v[44:47]
    buffer_store_dwordx4 v[112:115], v5, s[36:39], 0 offen offset:0 sc1
    v_mfma_f32_16x16x32_bf16 v[44:47], v[244:247], v[72:75], v[44:47]
    v_mfma_f32_16x16x32_bf16 v[44:47], v[252:255], v[76:79], v[44:47]
    s_nop 9
    v_fma_f32 v116, 2.0, v44, v116
    v_fma_f32 v117, 2.0, v45, v117
    v_fma_f32 v118, 2.0, v46, v118
    v_fma_f32 v119, 2.0, v47, v119
    buffer_store_dwordx4 v[116:119], v5, s[36:39], 0 offen offset:64 sc1
    s_endpgm
K1_B_COMP:
    s_lshl_b32 s49, s5, 2
    s_add_u32 s49, s49, s3
    s_lshl_b32 s54, s49, 11
    s_add_u32 s54, s54, 0x100000
    s_lshl_b32 s55, s49, 7
    s_add_u32 s55, s55, 0xe4000
    v_mov_b32 v32, 0
    s_cmp_lg_u32 s4, 0
    s_cbranch_scc1 ATZ0
    v_mov_b32 v28, 0
    v_mov_b32 v29, 0
    v_mov_b32 v30, 0
    v_mov_b32 v31, 0
    v_lshlrev_b32 v36, 4, v2
    buffer_store_dwordx4 v[28:31], v36, s[20:23], s54 offen sc1
    buffer_store_dwordx4 v[28:31], v36, s[20:23], s54 offen offset:1024 sc1
ATZ0:
    v_lshlrev_b32 v248, 4, v2
    s_lshl_b32 s42, s7, 15
    s_lshl_b32 s43, s3, 13
    s_add_u32 s42, s42, s43
    s_and_b32 s43, s6, 1
    s_lshl_b32 s43, s43, 20
    s_add_u32 s42, s42, s43
    s_add_u32 s43, s42, 4096
    buffer_load_dwordx4 v[252:255], v248, s[8:11], s42 offen offset:0
    buffer_load_dwordx4 v[252:255], v248, s[8:11], s42 offen offset:1024
    buffer_load_dwordx4 v[252:255], v248, s[8:11], s42 offen offset:2048
    buffer_load_dwordx4 v[252:255], v248, s[8:11], s42 offen offset:3072
    buffer_load_dwordx4 v[252:255], v248, s[8:11], s43 offen offset:0
    buffer_load_dwordx4 v[252:255], v248, s[8:11], s43 offen offset:1024
    buffer_load_dwordx4 v[252:255], v248, s[8:11], s43 offen offset:2048
    buffer_load_dwordx4 v[252:255], v248, s[8:11], s43 offen offset:3072
    v_and_b32 v249, 31, v2
    v_lshlrev_b32 v249, 4, v249
    v_lshrrev_b32 v250, 5, v2
    v_lshl_add_u32 v251, v250, 10, v249
    v_mul_u32_u24 v250, 3072, v250
    v_add_u32 v250, v250, v249
    v_add_u32 v250, 0x800, v250
    s_lshl_b32 s42, s7, 4
    s_lshl_b32 s43, s3, 2
    s_add_u32 s42, s42, s43
    s_mul_i32 s42, s42, 3072
    s_and_b32 s43, s6, 2
    s_lshl_b32 s43, s43, 8
    s_add_u32 s42, s42, s43
    s_add_u32 s43, s42, 0
    buffer_load_dwordx4 v[252:255], v251, s[12:15], s43 offen
    buffer_load_dwordx4 v[252:255], v250, s[12:15], s43 offen
    s_add_u32 s43, s42, 3072
    buffer_load_dwordx4 v[252:255], v251, s[12:15], s43 offen
    s_add_u32 s43, s42, 6144
    buffer_load_dwordx4 v[252:255], v251, s[12:15], s43 offen
    buffer_load_dwordx4 v[252:255], v250, s[12:15], s43 offen
    s_add_u32 s43, s42, 9216
    buffer_load_dwordx4 v[252:255], v251, s[12:15], s43 offen
    v_lshrrev_b32 v3, 4, v2
    v_and_b32 v4, 15, v2
    v_lshlrev_b32 v5, 7, v4
    v_lshrrev_b32 v6, 1, v4
    v_xor_b32 v6, v3, v6
    v_lshl_add_u32 v5, v6, 4, v5
    v_xor_b32 v6, 64, v5
    v_add_u32 v8, 0x0, v5
    v_add_u32 v9, 0x0, v6
    v_add_u32 v10, 0xa000, v5
    v_add_u32 v11, 0xa000, v6
    v_add_u32 v12, 0x14000, v5
    v_add_u32 v13, 0x14000, v6
    v_add_u32 v14, 0x1e000, v5
    v_add_u32 v15, 0x1e000, v6
    v_lshrrev_b32 v5, 2, v2
    v_and_b32 v5, 3, v5
    v_and_b32 v6, 3, v2
    v_lshl_add_u32 v7, v3, 3, v5
    v_lshlrev_b32 v33, 8, v7
    v_lshl_add_u32 v33, v6, 3, v33
    v_xor_b32 v34, s3, v5
    v_and_b32 v35, 1, v3
    v_lshl_add_u32 v34, v35, 2, v34
    v_lshl_add_u32 v33, v34, 5, v33
    v_xor_b32 v34, 128, v33
    v_add_u32 v16, 0x4000, v33
    v_add_u32 v17, 0x4000, v34
    v_add_u32 v18, 0xe000, v33
    v_add_u32 v19, 0xe000, v34
    v_add_u32 v20, 0x18000, v33
    v_add_u32 v21, 0x18000, v34
    v_add_u32 v22, 0x22000, v33
    v_add_u32 v23, 0x22000, v34
    v_lshlrev_b32 v33, 7, v7
    v_lshl_add_u32 v33, v6, 3, v33
    v_lshrrev_b32 v34, 1, v5
    v_lshl_add_u32 v34, v35, 1, v34
    v_xor_b32 v34, s3, v34
    v_lshl_add_u32 v33, v34, 5, v33
    v_add_u32 v24, 0x8000, v33
    v_add_u32 v25, 0x12000, v33
    v_add_u32 v26, 0x1c000, v33
    v_add_u32 v27, 0x26000, v33
    s_waitcnt lgkmcnt(0)
    s_add_u32 s40, s40, 1
    s_xor_b32 s41, s40, 0x9e3779b9
    s_barrier
    ds_read_b64_tr_b16 v[192:193], v16 offset:0
    ds_read_b64_tr_b16 v[194:195], v16 offset:1024
    ds_read_b64_tr_b16 v[196:197], v17 offset:0
    ds_read_b64_tr_b16 v[198:199], v17 offset:1024
    ds_read_b64_tr_b16 v[200:201], v24 offset:0
    ds_read_b64_tr_b16 v[202:203], v24 offset:512
    ds_read_b128 v[160:163], v8 offset:0
    ds_read_b128 v[164:167], v8 offset:2048
    ds_read_b128 v[168:171], v8 offset:4096
    ds_read_b128 v[172:175], v8 offset:6144
    ds_read_b128 v[176:179], v8 offset:8192
    ds_read_b128 v[180:183], v8 offset:10240
    ds_read_b128 v[184:187], v8 offset:12288
    ds_read_b128 v[188:191], v8 offset:14336
    s_waitcnt lgkmcnt(0)
    v_mfma_f32_16x16x32_bf16 v[64:67], v[160:163], v[192:195], 0
    ds_read_b64_tr_b16 v[236:237], v16 offset:8192
    v_mfma_f32_16x16x32_bf16 v[96:99], v[160:163], v[196:199], 0
    ds_read_b64_tr_b16 v[238:239], v16 offset:9216
    v_mfma_f32_16x16x32_bf16 v[128:131], v[200:203], v[160:163], 0
    v_mfma_f32_16x16x32_bf16 v[68:71], v[164:167], v[192:195], 0
    ds_read_b64_tr_b16 v[240:241], v17 offset:8192
    v_mfma_f32_16x16x32_bf16 v[100:103], v[164:167], v[196:199], 0
    v_mfma_f32_16x16x32_bf16 v[132:135], v[200:203], v[164:167], 0
    ds_read_b64_tr_b16 v[242:243], v17 offset:9216
    v_mfma_f32_16x16x32_bf16 v[72:75], v[168:171], v[192:195], 0
    ds_read_b64_tr_b16 v[244:245], v24 offset:4096
    v_mfma_f32_16x16x32_bf16 v[104:107], v[168:171], v[196:199], 0
    v_mfma_f32_16x16x32_bf16 v[136:139], v[200:203], v[168:171], 0
    ds_read_b64_tr_b16 v[246:247], v24 offset:4608
    v_mfma_f32_16x16x32_bf16 v[76:79], v[172:175], v[192:195], 0
    v_mfma_f32_16x16x32_bf16 v[108:111], v[172:175], v[196:199], 0
    ds_read_b128 v[204:207], v9 offset:0
    v_mfma_f32_16x16x32_bf16 v[140:143], v[200:203], v[172:175], 0
    v_mfma_f32_16x16x32_bf16 v[80:83], v[176:179], v[192:195], 0
    ds_read_b128 v[208:211], v9 offset:2048
    v_mfma_f32_16x16x32_bf16 v[112:115], v[176:179], v[196:199], 0
    ds_read_b128 v[212:215], v9 offset:4096
    v_mfma_f32_16x16x32_bf16 v[144:147], v[200:203], v[176:179], 0
    v_mfma_f32_16x16x32_bf16 v[84:87], v[180:183], v[192:195], 0
    ds_read_b128 v[216:219], v9 offset:6144
    v_mfma_f32_16x16x32_bf16 v[116:119], v[180:183], v[196:199], 0
    v_mfma_f32_16x16x32_bf16 v[148:151], v[200:203], v[180:183], 0
    ds_read_b128 v[220:223], v9 offset:8192
    v_mfma_f32_16x16x32_bf16 v[88:91], v[184:187], v[192:195], 0
    ds_read_b128 v[224:227], v9 offset:10240
    v_mfma_f32_16x16x32_bf16 v[120:123], v[184:187], v[196:199], 0
    v_mfma_f32_16x16x32_bf16 v[152:155], v[200:203], v[184:187], 0
    ds_read_b128 v[228:231], v9 offset:12288
    v_mfma_f32_16x16x32_bf16 v[92:95], v[188:191], v[192:195], 0
    v_mfma_f32_16x16x32_bf16 v[124:127], v[188:191], v[196:199], 0
    ds_read_b128 v[232:235], v9 offset:14336
    v_mfma_f32_16x16x32_bf16 v[156:159], v[200:203], v[188:191], 0
    s_barrier
    s_waitcnt lgkmcnt(0)
    v_mfma_f32_16x16x32_bf16 v[64:67], v[204:207], v[236:239], v[64:67]
    ds_read_b64_tr_b16 v[192:193], v18 offset:0
    v_mfma_f32_16x16x32_bf16 v[96:99], v[204:207], v[240:243], v[96:99]
    ds_read_b64_tr_b16 v[194:195], v18 offset:1024
    v_mfma_f32_16x16x32_bf16 v[128:131], v[244:247], v[204:207], v[128:131]
    v_mfma_f32_16x16x32_bf16 v[68:71], v[208:211], v[236:239], v[68:71]
    ds_read_b64_tr_b16 v[196:197], v19 offset:0
    v_mfma_f32_16x16x32_bf16 v[100:103], v[208:211], v[240:243], v[100:103]
    v_mfma_f32_16x16x32_bf16 v[132:135], v[244:247], v[208:211], v[132:135]
    ds_read_b64_tr_b16 v[198:199], v19 offset:1024
    v_mfma_f32_16x16x32_bf16 v[72:75], v[212:215], v[236:239], v[72:75]
    ds_read_b64_tr_b16 v[200:201], v25 offset:0
    v_mfma_f32_16x16x32_bf16 v[104:107], v[212:215], v[240:243], v[104:107]
    v_mfma_f32_16x16x32_bf16 v[136:139], v[244:247], v[212:215], v[136:139]
    ds_read_b64_tr_b16 v[202:203], v25 offset:512
    v_mfma_f32_16x16x32_bf16 v[76:79], v[216:219], v[236:239], v[76:79]
    v_mfma_f32_16x16x32_bf16 v[108:111], v[216:219], v[240:243], v[108:111]
    ds_read_b128 v[160:163], v10 offset:0
    v_mfma_f32_16x16x32_bf16 v[140:143], v[244:247], v[216:219], v[140:143]
    v_mfma_f32_16x16x32_bf16 v[80:83], v[220:223], v[236:239], v[80:83]
    ds_read_b128 v[164:167], v10 offset:2048
    v_mfma_f32_16x16x32_bf16 v[112:115], v[220:223], v[240:243], v[112:115]
    ds_read_b128 v[168:171], v10 offset:4096
    v_mfma_f32_16x16x32_bf16 v[144:147], v[244:247], v[220:223], v[144:147]
    v_mfma_f32_16x16x32_bf16 v[84:87], v[224:227], v[236:239], v[84:87]
    ds_read_b128 v[172:175], v10 offset:6144
    v_mfma_f32_16x16x32_bf16 v[116:119], v[224:227], v[240:243], v[116:119]
    v_mfma_f32_16x16x32_bf16 v[148:151], v[244:247], v[224:227], v[148:151]
    ds_read_b128 v[176:179], v10 offset:8192
    v_mfma_f32_16x16x32_bf16 v[88:91], v[228:231], v[236:239], v[88:91]
    ds_read_b128 v[180:183], v10 offset:10240
    v_mfma_f32_16x16x32_bf16 v[120:123], v[228:231], v[240:243], v[120:123]
    v_mfma_f32_16x16x32_bf16 v[152:155], v[244:247], v[228:231], v[152:155]
    ds_read_b128 v[184:187], v10 offset:12288
    v_mfma_f32_16x16x32_bf16 v[92:95], v[232:235], v[236:239], v[92:95]
    v_mfma_f32_16x16x32_bf16 v[124:127], v[232:235], v[240:243], v[124:127]
    ds_read_b128 v[188:191], v10 offset:14336
    v_mfma_f32_16x16x32_bf16 v[156:159], v[244:247], v[232:235], v[156:159]
    s_waitcnt lgkmcnt(0)
    v_mfma_f32_16x16x32_bf16 v[64:67], v[160:163], v[192:195], v[64:67]
    ds_read_b64_tr_b16 v[236:237], v18 offset:8192
    v_mfma_f32_16x16x32_bf16 v[96:99], v[160:163], v[196:199], v[96:99]
    ds_read_b64_tr_b16 v[238:239], v18 offset:9216
    v_mfma_f32_16x16x32_bf16 v[128:131], v[200:203], v[160:163], v[128:131]
    v_mfma_f32_16x16x32_bf16 v[68:71], v[164:167], v[192:195], v[68:71]
    ds_read_b64_tr_b16 v[240:241], v19 offset:8192
    v_mfma_f32_16x16x32_bf16 v[100:103], v[164:167], v[196:199], v[100:103]
    v_mfma_f32_16x16x32_bf16 v[132:135], v[200:203], v[164:167], v[132:135]
    ds_read_b64_tr_b16 v[242:243], v19 offset:9216
    v_mfma_f32_16x16x32_bf16 v[72:75], v[168:171], v[192:195], v[72:75]
    ds_read_b64_tr_b16 v[244:245], v25 offset:4096
    v_mfma_f32_16x16x32_bf16 v[104:107], v[168:171], v[196:199], v[104:107]
    v_mfma_f32_16x16x32_bf16 v[136:139], v[200:203], v[168:171], v[136:139]
    ds_read_b64_tr_b16 v[246:247], v25 offset:4608
    v_mfma_f32_16x16x32_bf16 v[76:79], v[172:175], v[192:195], v[76:79]
    v_mfma_f32_16x16x32_bf16 v[108:111], v[172:175], v[196:199], v[108:111]
    ds_read_b128 v[204:207], v11 offset:0
    v_mfma_f32_16x16x32_bf16 v[140:143], v[200:203], v[172:175], v[140:143]
    v_mfma_f32_16x16x32_bf16 v[80:83], v[176:179], v[192:195], v[80:83]
    ds_read_b128 v[208:211], v11 offset:2048
    v_mfma_f32_16x16x32_bf16 v[112:115], v[176:179], v[196:199], v[112:115]
    ds_read_b128 v[212:215], v11 offset:4096
    v_mfma_f32_16x16x32_bf16 v[144:147], v[200:203], v[176:179], v[144:147]
    v_mfma_f32_16x16x32_bf16 v[84:87], v[180:183], v[192:195], v[84:87]
    ds_read_b128 v[216:219], v11 offset:6144
    v_mfma_f32_16x16x32_bf16 v[116:119], v[180:183], v[196:199], v[116:119]
    v_mfma_f32_16x16x32_bf16 v[148:151], v[200:203], v[180:183], v[148:151]
    ds_read_b128 v[220:223], v11 offset:8192
    v_mfma_f32_16x16x32_bf16 v[88:91], v[184:187], v[192:195], v[88:91]
    ds_read_b128 v[224:227], v11 offset:10240
    v_mfma_f32_16x16x32_bf16 v[120:123], v[184:187], v[196:199], v[120:123]
    v_mfma_f32_16x16x32_bf16 v[152:155], v[200:203], v[184:187], v[152:155]
    ds_read_b128 v[228:231], v11 offset:12288
    v_mfma_f32_16x16x32_bf16 v[92:95], v[188:191], v[192:195], v[92:95]
    v_mfma_f32_16x16x32_bf16 v[124:127], v[188:191], v[196:199], v[124:127]
    ds_read_b128 v[232:235], v11 offset:14336
    v_mfma_f32_16x16x32_bf16 v[156:159], v[200:203], v[188:191], v[156:159]
    s_barrier
    s_waitcnt lgkmcnt(0)
    v_mfma_f32_16x16x32_bf16 v[64:67], v[204:207], v[236:239], v[64:67]
    ds_read_b64_tr_b16 v[192:193], v20 offset:0
    v_mfma_f32_16x16x32_bf16 v[96:99], v[204:207], v[240:243], v[96:99]
    ds_read_b64_tr_b16 v[194:195], v20 offset:1024
    v_mfma_f32_16x16x32_bf16 v[128:131], v[244:247], v[204:207], v[128:131]
    v_mfma_f32_16x16x32_bf16 v[68:71], v[208:211], v[236:239], v[68:71]
    ds_read_b64_tr_b16 v[196:197], v21 offset:0
    v_mfma_f32_16x16x32_bf16 v[100:103], v[208:211], v[240:243], v[100:103]
    v_mfma_f32_16x16x32_bf16 v[132:135], v[244:247], v[208:211], v[132:135]
    ds_read_b64_tr_b16 v[198:199], v21 offset:1024
    v_mfma_f32_16x16x32_bf16 v[72:75], v[212:215], v[236:239], v[72:75]
    ds_read_b64_tr_b16 v[200:201], v26 offset:0
    v_mfma_f32_16x16x32_bf16 v[104:107], v[212:215], v[240:243], v[104:107]
    v_mfma_f32_16x16x32_bf16 v[136:139], v[244:247], v[212:215], v[136:139]
    ds_read_b64_tr_b16 v[202:203], v26 offset:512
    v_mfma_f32_16x16x32_bf16 v[76:79], v[216:219], v[236:239], v[76:79]
    v_mfma_f32_16x16x32_bf16 v[108:111], v[216:219], v[240:243], v[108:111]
    ds_read_b128 v[160:163], v12 offset:0
    v_mfma_f32_16x16x32_bf16 v[140:143], v[244:247], v[216:219], v[140:143]
    v_mfma_f32_16x16x32_bf16 v[80:83], v[220:223], v[236:239], v[80:83]
    ds_read_b128 v[164:167], v12 offset:2048
    v_mfma_f32_16x16x32_bf16 v[112:115], v[220:223], v[240:243], v[112:115]
    ds_read_b128 v[168:171], v12 offset:4096
    v_mfma_f32_16x16x32_bf16 v[144:147], v[244:247], v[220:223], v[144:147]
    v_mfma_f32_16x16x32_bf16 v[84:87], v[224:227], v[236:239], v[84:87]
    ds_read_b128 v[172:175], v12 offset:6144
    v_mfma_f32_16x16x32_bf16 v[116:119], v[224:227], v[240:243], v[116:119]
    v_mfma_f32_16x16x32_bf16 v[148:151], v[244:247], v[224:227], v[148:151]
    ds_read_b128 v[176:179], v12 offset:8192
    v_mfma_f32_16x16x32_bf16 v[88:91], v[228:231], v[236:239], v[88:91]
    ds_read_b128 v[180:183], v12 offset:10240
    v_mfma_f32_16x16x32_bf16 v[120:123], v[228:231], v[240:243], v[120:123]
    v_mfma_f32_16x16x32_bf16 v[152:155], v[244:247], v[228:231], v[152:155]
    ds_read_b128 v[184:187], v12 offset:12288
    v_mfma_f32_16x16x32_bf16 v[92:95], v[232:235], v[236:239], v[92:95]
    v_mfma_f32_16x16x32_bf16 v[124:127], v[232:235], v[240:243], v[124:127]
    ds_read_b128 v[188:191], v12 offset:14336
    v_mfma_f32_16x16x32_bf16 v[156:159], v[244:247], v[232:235], v[156:159]
    s_waitcnt lgkmcnt(0)
    v_mfma_f32_16x16x32_bf16 v[64:67], v[160:163], v[192:195], v[64:67]
    ds_read_b64_tr_b16 v[236:237], v20 offset:8192
    v_mfma_f32_16x16x32_bf16 v[96:99], v[160:163], v[196:199], v[96:99]
    ds_read_b64_tr_b16 v[238:239], v20 offset:9216
    v_mfma_f32_16x16x32_bf16 v[128:131], v[200:203], v[160:163], v[128:131]
    v_mfma_f32_16x16x32_bf16 v[68:71], v[164:167], v[192:195], v[68:71]
    ds_read_b64_tr_b16 v[240:241], v21 offset:8192
    v_mfma_f32_16x16x32_bf16 v[100:103], v[164:167], v[196:199], v[100:103]
    v_mfma_f32_16x16x32_bf16 v[132:135], v[200:203], v[164:167], v[132:135]
    ds_read_b64_tr_b16 v[242:243], v21 offset:9216
    v_mfma_f32_16x16x32_bf16 v[72:75], v[168:171], v[192:195], v[72:75]
    ds_read_b64_tr_b16 v[244:245], v26 offset:4096
    v_mfma_f32_16x16x32_bf16 v[104:107], v[168:171], v[196:199], v[104:107]
    v_mfma_f32_16x16x32_bf16 v[136:139], v[200:203], v[168:171], v[136:139]
    ds_read_b64_tr_b16 v[246:247], v26 offset:4608
    v_mfma_f32_16x16x32_bf16 v[76:79], v[172:175], v[192:195], v[76:79]
    v_mfma_f32_16x16x32_bf16 v[108:111], v[172:175], v[196:199], v[108:111]
    ds_read_b128 v[204:207], v13 offset:0
    v_mfma_f32_16x16x32_bf16 v[140:143], v[200:203], v[172:175], v[140:143]
    v_mfma_f32_16x16x32_bf16 v[80:83], v[176:179], v[192:195], v[80:83]
    ds_read_b128 v[208:211], v13 offset:2048
    v_mfma_f32_16x16x32_bf16 v[112:115], v[176:179], v[196:199], v[112:115]
    ds_read_b128 v[212:215], v13 offset:4096
    v_mfma_f32_16x16x32_bf16 v[144:147], v[200:203], v[176:179], v[144:147]
    v_mfma_f32_16x16x32_bf16 v[84:87], v[180:183], v[192:195], v[84:87]
    ds_read_b128 v[216:219], v13 offset:6144
    v_mfma_f32_16x16x32_bf16 v[116:119], v[180:183], v[196:199], v[116:119]
    v_mfma_f32_16x16x32_bf16 v[148:151], v[200:203], v[180:183], v[148:151]
    ds_read_b128 v[220:223], v13 offset:8192
    v_mfma_f32_16x16x32_bf16 v[88:91], v[184:187], v[192:195], v[88:91]
    ds_read_b128 v[224:227], v13 offset:10240
    v_mfma_f32_16x16x32_bf16 v[120:123], v[184:187], v[196:199], v[120:123]
    v_mfma_f32_16x16x32_bf16 v[152:155], v[200:203], v[184:187], v[152:155]
    ds_read_b128 v[228:231], v13 offset:12288
    v_mfma_f32_16x16x32_bf16 v[92:95], v[188:191], v[192:195], v[92:95]
    v_mfma_f32_16x16x32_bf16 v[124:127], v[188:191], v[196:199], v[124:127]
    ds_read_b128 v[232:235], v13 offset:14336
    v_mfma_f32_16x16x32_bf16 v[156:159], v[200:203], v[188:191], v[156:159]
    s_cmp_lg_u32 s4, 0
    s_cbranch_scc1 ATZ1
    v_mov_b32 v28, s40
    v_mov_b32 v29, s41
    s_waitcnt vmcnt(0)
    s_mov_b64 exec, 1
    buffer_store_dwordx2 v[28:29], v32, s[20:23], s55 offen sc1
    s_mov_b64 exec, -1
ATZ1:
    s_barrier
    s_waitcnt lgkmcnt(0)
    v_mfma_f32_16x16x32_bf16 v[64:67], v[204:207], v[236:239], v[64:67]
    ds_read_b64_tr_b16 v[192:193], v22 offset:0
    v_mfma_f32_16x16x32_bf16 v[96:99], v[204:207], v[240:243], v[96:99]
    ds_read_b64_tr_b16 v[194:195], v22 offset:1024
    v_mfma_f32_16x16x32_bf16 v[128:131], v[244:247], v[204:207], v[128:131]
    v_mfma_f32_16x16x32_bf16 v[68:71], v[208:211], v[236:239], v[68:71]
    ds_read_b64_tr_b16 v[196:197], v23 offset:0
    v_mfma_f32_16x16x32_bf16 v[100:103], v[208:211], v[240:243], v[100:103]
    v_mfma_f32_16x16x32_bf16 v[132:135], v[244:247], v[208:211], v[132:135]
    ds_read_b64_tr_b16 v[198:199], v23 offset:1024
    v_mfma_f32_16x16x32_bf16 v[72:75], v[212:215], v[236:239], v[72:75]
    ds_read_b64_tr_b16 v[200:201], v27 offset:0
    v_mfma_f32_16x16x32_bf16 v[104:107], v[212:215], v[240:243], v[104:107]
    v_mfma_f32_16x16x32_bf16 v[136:139], v[244:247], v[212:215], v[136:139]
    ds_read_b64_tr_b16 v[202:203], v27 offset:512
    v_mfma_f32_16x16x32_bf16 v[76:79], v[216:219], v[236:239], v[76:79]
    v_mfma_f32_16x16x32_bf16 v[108:111], v[216:219], v[240:243], v[108:111]
    ds_read_b128 v[160:163], v14 offset:0
    v_mfma_f32_16x16x32_bf16 v[140:143], v[244:247], v[216:219], v[140:143]
    v_mfma_f32_16x16x32_bf16 v[80:83], v[220:223], v[236:239], v[80:83]
    ds_read_b128 v[164:167], v14 offset:2048
    v_mfma_f32_16x16x32_bf16 v[112:115], v[220:223], v[240:243], v[112:115]
    ds_read_b128 v[168:171], v14 offset:4096
    v_mfma_f32_16x16x32_bf16 v[144:147], v[244:247], v[220:223], v[144:147]
    v_mfma_f32_16x16x32_bf16 v[84:87], v[224:227], v[236:239], v[84:87]
    ds_read_b128 v[172:175], v14 offset:6144
    v_mfma_f32_16x16x32_bf16 v[116:119], v[224:227], v[240:243], v[116:119]
    v_mfma_f32_16x16x32_bf16 v[148:151], v[244:247], v[224:227], v[148:151]
    ds_read_b128 v[176:179], v14 offset:8192
    v_mfma_f32_16x16x32_bf16 v[88:91], v[228:231], v[236:239], v[88:91]
    ds_read_b128 v[180:183], v14 offset:10240
    v_mfma_f32_16x16x32_bf16 v[120:123], v[228:231], v[240:243], v[120:123]
    v_mfma_f32_16x16x32_bf16 v[152:155], v[244:247], v[228:231], v[152:155]
    ds_read_b128 v[184:187], v14 offset:12288
    v_mfma_f32_16x16x32_bf16 v[92:95], v[232:235], v[236:239], v[92:95]
    v_mfma_f32_16x16x32_bf16 v[124:127], v[232:235], v[240:243], v[124:127]
    ds_read_b128 v[188:191], v14 offset:14336
    v_mfma_f32_16x16x32_bf16 v[156:159], v[244:247], v[232:235], v[156:159]
    s_waitcnt lgkmcnt(0)
    v_mfma_f32_16x16x32_bf16 v[64:67], v[160:163], v[192:195], v[64:67]
    ds_read_b64_tr_b16 v[236:237], v22 offset:8192
    v_mfma_f32_16x16x32_bf16 v[96:99], v[160:163], v[196:199], v[96:99]
    ds_read_b64_tr_b16 v[238:239], v22 offset:9216
    v_mfma_f32_16x16x32_bf16 v[128:131], v[200:203], v[160:163], v[128:131]
    v_mfma_f32_16x16x32_bf16 v[68:71], v[164:167], v[192:195], v[68:71]
    ds_read_b64_tr_b16 v[240:241], v23 offset:8192
    v_mfma_f32_16x16x32_bf16 v[100:103], v[164:167], v[196:199], v[100:103]
    v_mfma_f32_16x16x32_bf16 v[132:135], v[200:203], v[164:167], v[132:135]
    ds_read_b64_tr_b16 v[242:243], v23 offset:9216
    v_mfma_f32_16x16x32_bf16 v[72:75], v[168:171], v[192:195], v[72:75]
    ds_read_b64_tr_b16 v[244:245], v27 offset:4096
    v_mfma_f32_16x16x32_bf16 v[104:107], v[168:171], v[196:199], v[104:107]
    v_mfma_f32_16x16x32_bf16 v[136:139], v[200:203], v[168:171], v[136:139]
    ds_read_b64_tr_b16 v[246:247], v27 offset:4608
    v_mfma_f32_16x16x32_bf16 v[76:79], v[172:175], v[192:195], v[76:79]
    v_mfma_f32_16x16x32_bf16 v[108:111], v[172:175], v[196:199], v[108:111]
    ds_read_b128 v[204:207], v15 offset:0
    v_mfma_f32_16x16x32_bf16 v[140:143], v[200:203], v[172:175], v[140:143]
    v_mfma_f32_16x16x32_bf16 v[80:83], v[176:179], v[192:195], v[80:83]
    ds_read_b128 v[208:211], v15 offset:2048
    v_mfma_f32_16x16x32_bf16 v[112:115], v[176:179], v[196:199], v[112:115]
    ds_read_b128 v[212:215], v15 offset:4096
    v_mfma_f32_16x16x32_bf16 v[144:147], v[200:203], v[176:179], v[144:147]
    v_mfma_f32_16x16x32_bf16 v[84:87], v[180:183], v[192:195], v[84:87]
    ds_read_b128 v[216:219], v15 offset:6144
    v_mfma_f32_16x16x32_bf16 v[116:119], v[180:183], v[196:199], v[116:119]
    v_mfma_f32_16x16x32_bf16 v[148:151], v[200:203], v[180:183], v[148:151]
    ds_read_b128 v[220:223], v15 offset:8192
    v_mfma_f32_16x16x32_bf16 v[88:91], v[184:187], v[192:195], v[88:91]
    ds_read_b128 v[224:227], v15 offset:10240
    v_mfma_f32_16x16x32_bf16 v[120:123], v[184:187], v[196:199], v[120:123]
    v_mfma_f32_16x16x32_bf16 v[152:155], v[200:203], v[184:187], v[152:155]
    ds_read_b128 v[228:231], v15 offset:12288
    v_mfma_f32_16x16x32_bf16 v[92:95], v[188:191], v[192:195], v[92:95]
    v_mfma_f32_16x16x32_bf16 v[124:127], v[188:191], v[196:199], v[124:127]
    ds_read_b128 v[232:235], v15 offset:14336
    v_mfma_f32_16x16x32_bf16 v[156:159], v[200:203], v[188:191], v[156:159]
    s_barrier
    s_waitcnt lgkmcnt(0)
    v_mfma_f32_16x16x32_bf16 v[64:67], v[204:207], v[236:239], v[64:67]
    ds_read_b64_tr_b16 v[192:193], v16 offset:0
    v_mfma_f32_16x16x32_bf16 v[96:99], v[204:207], v[240:243], v[96:99]
    ds_read_b64_tr_b16 v[194:195], v16 offset:1024
    v_mfma_f32_16x16x32_bf16 v[128:131], v[244:247], v[204:207], v[128:131]
    v_mfma_f32_16x16x32_bf16 v[68:71], v[208:211], v[236:239], v[68:71]
    ds_read_b64_tr_b16 v[196:197], v17 offset:0
    v_mfma_f32_16x16x32_bf16 v[100:103], v[208:211], v[240:243], v[100:103]
    v_mfma_f32_16x16x32_bf16 v[132:135], v[244:247], v[208:211], v[132:135]
    ds_read_b64_tr_b16 v[198:199], v17 offset:1024
    v_mfma_f32_16x16x32_bf16 v[72:75], v[212:215], v[236:239], v[72:75]
    ds_read_b64_tr_b16 v[200:201], v24 offset:0
    v_mfma_f32_16x16x32_bf16 v[104:107], v[212:215], v[240:243], v[104:107]
    v_mfma_f32_16x16x32_bf16 v[136:139], v[244:247], v[212:215], v[136:139]
    ds_read_b64_tr_b16 v[202:203], v24 offset:512
    v_mfma_f32_16x16x32_bf16 v[76:79], v[216:219], v[236:239], v[76:79]
    v_mfma_f32_16x16x32_bf16 v[108:111], v[216:219], v[240:243], v[108:111]
    ds_read_b128 v[160:163], v8 offset:0
    v_mfma_f32_16x16x32_bf16 v[140:143], v[244:247], v[216:219], v[140:143]
    v_mfma_f32_16x16x32_bf16 v[80:83], v[220:223], v[236:239], v[80:83]
    ds_read_b128 v[164:167], v8 offset:2048
    v_mfma_f32_16x16x32_bf16 v[112:115], v[220:223], v[240:243], v[112:115]
    ds_read_b128 v[168:171], v8 offset:4096
    v_mfma_f32_16x16x32_bf16 v[144:147], v[244:247], v[220:223], v[144:147]
    v_mfma_f32_16x16x32_bf16 v[84:87], v[224:227], v[236:239], v[84:87]
    ds_read_b128 v[172:175], v8 offset:6144
    v_mfma_f32_16x16x32_bf16 v[116:119], v[224:227], v[240:243], v[116:119]
    v_mfma_f32_16x16x32_bf16 v[148:151], v[244:247], v[224:227], v[148:151]
    ds_read_b128 v[176:179], v8 offset:8192
    v_mfma_f32_16x16x32_bf16 v[88:91], v[228:231], v[236:239], v[88:91]
    ds_read_b128 v[180:183], v8 offset:10240
    v_mfma_f32_16x16x32_bf16 v[120:123], v[228:231], v[240:243], v[120:123]
    v_mfma_f32_16x16x32_bf16 v[152:155], v[244:247], v[228:231], v[152:155]
    ds_read_b128 v[184:187], v8 offset:12288
    v_mfma_f32_16x16x32_bf16 v[92:95], v[232:235], v[236:239], v[92:95]
    v_mfma_f32_16x16x32_bf16 v[124:127], v[232:235], v[240:243], v[124:127]
    ds_read_b128 v[188:191], v8 offset:14336
    v_mfma_f32_16x16x32_bf16 v[156:159], v[244:247], v[232:235], v[156:159]
    s_waitcnt lgkmcnt(0)
    v_mfma_f32_16x16x32_bf16 v[64:67], v[160:163], v[192:195], v[64:67]
    ds_read_b64_tr_b16 v[236:237], v16 offset:8192
    v_mfma_f32_16x16x32_bf16 v[96:99], v[160:163], v[196:199], v[96:99]
    ds_read_b64_tr_b16 v[238:239], v16 offset:9216
    v_mfma_f32_16x16x32_bf16 v[128:131], v[200:203], v[160:163], v[128:131]
    v_mfma_f32_16x16x32_bf16 v[68:71], v[164:167], v[192:195], v[68:71]
    ds_read_b64_tr_b16 v[240:241], v17 offset:8192
    v_mfma_f32_16x16x32_bf16 v[100:103], v[164:167], v[196:199], v[100:103]
    v_mfma_f32_16x16x32_bf16 v[132:135], v[200:203], v[164:167], v[132:135]
    ds_read_b64_tr_b16 v[242:243], v17 offset:9216
    v_mfma_f32_16x16x32_bf16 v[72:75], v[168:171], v[192:195], v[72:75]
    ds_read_b64_tr_b16 v[244:245], v24 offset:4096
    v_mfma_f32_16x16x32_bf16 v[104:107], v[168:171], v[196:199], v[104:107]
    v_mfma_f32_16x16x32_bf16 v[136:139], v[200:203], v[168:171], v[136:139]
    ds_read_b64_tr_b16 v[246:247], v24 offset:4608
    v_mfma_f32_16x16x32_bf16 v[76:79], v[172:175], v[192:195], v[76:79]
    v_mfma_f32_16x16x32_bf16 v[108:111], v[172:175], v[196:199], v[108:111]
    ds_read_b128 v[204:207], v9 offset:0
    v_mfma_f32_16x16x32_bf16 v[140:143], v[200:203], v[172:175], v[140:143]
    v_mfma_f32_16x16x32_bf16 v[80:83], v[176:179], v[192:195], v[80:83]
    ds_read_b128 v[208:211], v9 offset:2048
    v_mfma_f32_16x16x32_bf16 v[112:115], v[176:179], v[196:199], v[112:115]
    ds_read_b128 v[212:215], v9 offset:4096
    v_mfma_f32_16x16x32_bf16 v[144:147], v[200:203], v[176:179], v[144:147]
    v_mfma_f32_16x16x32_bf16 v[84:87], v[180:183], v[192:195], v[84:87]
    ds_read_b128 v[216:219], v9 offset:6144
    v_mfma_f32_16x16x32_bf16 v[116:119], v[180:183], v[196:199], v[116:119]
    v_mfma_f32_16x16x32_bf16 v[148:151], v[200:203], v[180:183], v[148:151]
    ds_read_b128 v[220:223], v9 offset:8192
    v_mfma_f32_16x16x32_bf16 v[88:91], v[184:187], v[192:195], v[88:91]
    ds_read_b128 v[224:227], v9 offset:10240
    v_mfma_f32_16x16x32_bf16 v[120:123], v[184:187], v[196:199], v[120:123]
    v_mfma_f32_16x16x32_bf16 v[152:155], v[200:203], v[184:187], v[152:155]
    ds_read_b128 v[228:231], v9 offset:12288
    v_mfma_f32_16x16x32_bf16 v[92:95], v[188:191], v[192:195], v[92:95]
    v_mfma_f32_16x16x32_bf16 v[124:127], v[188:191], v[196:199], v[124:127]
    ds_read_b128 v[232:235], v9 offset:14336
    v_mfma_f32_16x16x32_bf16 v[156:159], v[200:203], v[188:191], v[156:159]
    s_barrier
    s_waitcnt lgkmcnt(0)
    v_mfma_f32_16x16x32_bf16 v[64:67], v[204:207], v[236:239], v[64:67]
    ds_read_b64_tr_b16 v[192:193], v18 offset:0
    v_mfma_f32_16x16x32_bf16 v[96:99], v[204:207], v[240:243], v[96:99]
    ds_read_b64_tr_b16 v[194:195], v18 offset:1024
    v_mfma_f32_16x16x32_bf16 v[128:131], v[244:247], v[204:207], v[128:131]
    v_mfma_f32_16x16x32_bf16 v[68:71], v[208:211], v[236:239], v[68:71]
    ds_read_b64_tr_b16 v[196:197], v19 offset:0
    v_mfma_f32_16x16x32_bf16 v[100:103], v[208:211], v[240:243], v[100:103]
    v_mfma_f32_16x16x32_bf16 v[132:135], v[244:247], v[208:211], v[132:135]
    ds_read_b64_tr_b16 v[198:199], v19 offset:1024
    v_mfma_f32_16x16x32_bf16 v[72:75], v[212:215], v[236:239], v[72:75]
    ds_read_b64_tr_b16 v[200:201], v25 offset:0
    v_mfma_f32_16x16x32_bf16 v[104:107], v[212:215], v[240:243], v[104:107]
    v_mfma_f32_16x16x32_bf16 v[136:139], v[244:247], v[212:215], v[136:139]
    ds_read_b64_tr_b16 v[202:203], v25 offset:512
    v_mfma_f32_16x16x32_bf16 v[76:79], v[216:219], v[236:239], v[76:79]
    v_mfma_f32_16x16x32_bf16 v[108:111], v[216:219], v[240:243], v[108:111]
    ds_read_b128 v[160:163], v10 offset:0
    v_mfma_f32_16x16x32_bf16 v[140:143], v[244:247], v[216:219], v[140:143]
    v_mfma_f32_16x16x32_bf16 v[80:83], v[220:223], v[236:239], v[80:83]
    ds_read_b128 v[164:167], v10 offset:2048
    v_mfma_f32_16x16x32_bf16 v[112:115], v[220:223], v[240:243], v[112:115]
    ds_read_b128 v[168:171], v10 offset:4096
    v_mfma_f32_16x16x32_bf16 v[144:147], v[244:247], v[220:223], v[144:147]
    v_mfma_f32_16x16x32_bf16 v[84:87], v[224:227], v[236:239], v[84:87]
    ds_read_b128 v[172:175], v10 offset:6144
    v_mfma_f32_16x16x32_bf16 v[116:119], v[224:227], v[240:243], v[116:119]
    v_mfma_f32_16x16x32_bf16 v[148:151], v[244:247], v[224:227], v[148:151]
    ds_read_b128 v[176:179], v10 offset:8192
    v_mfma_f32_16x16x32_bf16 v[88:91], v[228:231], v[236:239], v[88:91]
    ds_read_b128 v[180:183], v10 offset:10240
    v_mfma_f32_16x16x32_bf16 v[120:123], v[228:231], v[240:243], v[120:123]
    v_mfma_f32_16x16x32_bf16 v[152:155], v[244:247], v[228:231], v[152:155]
    ds_read_b128 v[184:187], v10 offset:12288
    v_mfma_f32_16x16x32_bf16 v[92:95], v[232:235], v[236:239], v[92:95]
    v_mfma_f32_16x16x32_bf16 v[124:127], v[232:235], v[240:243], v[124:127]
    ds_read_b128 v[188:191], v10 offset:14336
    v_mfma_f32_16x16x32_bf16 v[156:159], v[244:247], v[232:235], v[156:159]
    s_waitcnt lgkmcnt(0)
    v_mfma_f32_16x16x32_bf16 v[64:67], v[160:163], v[192:195], v[64:67]
    ds_read_b64_tr_b16 v[236:237], v18 offset:8192
    v_mfma_f32_16x16x32_bf16 v[96:99], v[160:163], v[196:199], v[96:99]
    ds_read_b64_tr_b16 v[238:239], v18 offset:9216
    v_mfma_f32_16x16x32_bf16 v[128:131], v[200:203], v[160:163], v[128:131]
    v_mfma_f32_16x16x32_bf16 v[68:71], v[164:167], v[192:195], v[68:71]
    ds_read_b64_tr_b16 v[240:241], v19 offset:8192
    v_mfma_f32_16x16x32_bf16 v[100:103], v[164:167], v[196:199], v[100:103]
    v_mfma_f32_16x16x32_bf16 v[132:135], v[200:203], v[164:167], v[132:135]
    ds_read_b64_tr_b16 v[242:243], v19 offset:9216
    v_mfma_f32_16x16x32_bf16 v[72:75], v[168:171], v[192:195], v[72:75]
    ds_read_b64_tr_b16 v[244:245], v25 offset:4096
    v_mfma_f32_16x16x32_bf16 v[104:107], v[168:171], v[196:199], v[104:107]
    v_mfma_f32_16x16x32_bf16 v[136:139], v[200:203], v[168:171], v[136:139]
    ds_read_b64_tr_b16 v[246:247], v25 offset:4608
    v_mfma_f32_16x16x32_bf16 v[76:79], v[172:175], v[192:195], v[76:79]
    v_mfma_f32_16x16x32_bf16 v[108:111], v[172:175], v[196:199], v[108:111]
    ds_read_b128 v[204:207], v11 offset:0
    v_mfma_f32_16x16x32_bf16 v[140:143], v[200:203], v[172:175], v[140:143]
    v_mfma_f32_16x16x32_bf16 v[80:83], v[176:179], v[192:195], v[80:83]
    ds_read_b128 v[208:211], v11 offset:2048
    v_mfma_f32_16x16x32_bf16 v[112:115], v[176:179], v[196:199], v[112:115]
    ds_read_b128 v[212:215], v11 offset:4096
    v_mfma_f32_16x16x32_bf16 v[144:147], v[200:203], v[176:179], v[144:147]
    v_mfma_f32_16x16x32_bf16 v[84:87], v[180:183], v[192:195], v[84:87]
    ds_read_b128 v[216:219], v11 offset:6144
    v_mfma_f32_16x16x32_bf16 v[116:119], v[180:183], v[196:199], v[116:119]
    v_mfma_f32_16x16x32_bf16 v[148:151], v[200:203], v[180:183], v[148:151]
    ds_read_b128 v[220:223], v11 offset:8192
    v_mfma_f32_16x16x32_bf16 v[88:91], v[184:187], v[192:195], v[88:91]
    ds_read_b128 v[224:227], v11 offset:10240
    v_mfma_f32_16x16x32_bf16 v[120:123], v[184:187], v[196:199], v[120:123]
    v_mfma_f32_16x16x32_bf16 v[152:155], v[200:203], v[184:187], v[152:155]
    ds_read_b128 v[228:231], v11 offset:12288
    v_mfma_f32_16x16x32_bf16 v[92:95], v[188:191], v[192:195], v[92:95]
    v_mfma_f32_16x16x32_bf16 v[124:127], v[188:191], v[196:199], v[124:127]
    ds_read_b128 v[232:235], v11 offset:14336
    v_mfma_f32_16x16x32_bf16 v[156:159], v[200:203], v[188:191], v[156:159]
    s_barrier
    s_waitcnt lgkmcnt(0)
    v_mfma_f32_16x16x32_bf16 v[64:67], v[204:207], v[236:239], v[64:67]
    ds_read_b64_tr_b16 v[192:193], v20 offset:0
    v_mfma_f32_16x16x32_bf16 v[96:99], v[204:207], v[240:243], v[96:99]
    ds_read_b64_tr_b16 v[194:195], v20 offset:1024
    v_mfma_f32_16x16x32_bf16 v[128:131], v[244:247], v[204:207], v[128:131]
    v_mfma_f32_16x16x32_bf16 v[68:71], v[208:211], v[236:239], v[68:71]
    ds_read_b64_tr_b16 v[196:197], v21 offset:0
    v_mfma_f32_16x16x32_bf16 v[100:103], v[208:211], v[240:243], v[100:103]
    v_mfma_f32_16x16x32_bf16 v[132:135], v[244:247], v[208:211], v[132:135]
    ds_read_b64_tr_b16 v[198:199], v21 offset:1024
    v_mfma_f32_16x16x32_bf16 v[72:75], v[212:215], v[236:239], v[72:75]
    ds_read_b64_tr_b16 v[200:201], v26 offset:0
    v_mfma_f32_16x16x32_bf16 v[104:107], v[212:215], v[240:243], v[104:107]
    v_mfma_f32_16x16x32_bf16 v[136:139], v[244:247], v[212:215], v[136:139]
    ds_read_b64_tr_b16 v[202:203], v26 offset:512
    v_mfma_f32_16x16x32_bf16 v[76:79], v[216:219], v[236:239], v[76:79]
    v_mfma_f32_16x16x32_bf16 v[108:111], v[216:219], v[240:243], v[108:111]
    ds_read_b128 v[160:163], v12 offset:0
    v_mfma_f32_16x16x32_bf16 v[140:143], v[244:247], v[216:219], v[140:143]
    v_mfma_f32_16x16x32_bf16 v[80:83], v[220:223], v[236:239], v[80:83]
    ds_read_b128 v[164:167], v12 offset:2048
    v_mfma_f32_16x16x32_bf16 v[112:115], v[220:223], v[240:243], v[112:115]
    ds_read_b128 v[168:171], v12 offset:4096
    v_mfma_f32_16x16x32_bf16 v[144:147], v[244:247], v[220:223], v[144:147]
    v_mfma_f32_16x16x32_bf16 v[84:87], v[224:227], v[236:239], v[84:87]
    ds_read_b128 v[172:175], v12 offset:6144
    v_mfma_f32_16x16x32_bf16 v[116:119], v[224:227], v[240:243], v[116:119]
    v_mfma_f32_16x16x32_bf16 v[148:151], v[244:247], v[224:227], v[148:151]
    ds_read_b128 v[176:179], v12 offset:8192
    v_mfma_f32_16x16x32_bf16 v[88:91], v[228:231], v[236:239], v[88:91]
    ds_read_b128 v[180:183], v12 offset:10240
    v_mfma_f32_16x16x32_bf16 v[120:123], v[228:231], v[240:243], v[120:123]
    v_mfma_f32_16x16x32_bf16 v[152:155], v[244:247], v[228:231], v[152:155]
    ds_read_b128 v[184:187], v12 offset:12288
    v_mfma_f32_16x16x32_bf16 v[92:95], v[232:235], v[236:239], v[92:95]
    v_mfma_f32_16x16x32_bf16 v[124:127], v[232:235], v[240:243], v[124:127]
    ds_read_b128 v[188:191], v12 offset:14336
    v_mfma_f32_16x16x32_bf16 v[156:159], v[244:247], v[232:235], v[156:159]
    s_waitcnt lgkmcnt(0)
    v_mfma_f32_16x16x32_bf16 v[64:67], v[160:163], v[192:195], v[64:67]
    ds_read_b64_tr_b16 v[236:237], v20 offset:8192
    v_mfma_f32_16x16x32_bf16 v[96:99], v[160:163], v[196:199], v[96:99]
    ds_read_b64_tr_b16 v[238:239], v20 offset:9216
    v_mfma_f32_16x16x32_bf16 v[128:131], v[200:203], v[160:163], v[128:131]
    v_mfma_f32_16x16x32_bf16 v[68:71], v[164:167], v[192:195], v[68:71]
    ds_read_b64_tr_b16 v[240:241], v21 offset:8192
    v_mfma_f32_16x16x32_bf16 v[100:103], v[164:167], v[196:199], v[100:103]
    v_mfma_f32_16x16x32_bf16 v[132:135], v[200:203], v[164:167], v[132:135]
    ds_read_b64_tr_b16 v[242:243], v21 offset:9216
    v_mfma_f32_16x16x32_bf16 v[72:75], v[168:171], v[192:195], v[72:75]
    ds_read_b64_tr_b16 v[244:245], v26 offset:4096
    v_mfma_f32_16x16x32_bf16 v[104:107], v[168:171], v[196:199], v[104:107]
    v_mfma_f32_16x16x32_bf16 v[136:139], v[200:203], v[168:171], v[136:139]
    ds_read_b64_tr_b16 v[246:247], v26 offset:4608
    v_mfma_f32_16x16x32_bf16 v[76:79], v[172:175], v[192:195], v[76:79]
    v_mfma_f32_16x16x32_bf16 v[108:111], v[172:175], v[196:199], v[108:111]
    ds_read_b128 v[204:207], v13 offset:0
    v_mfma_f32_16x16x32_bf16 v[140:143], v[200:203], v[172:175], v[140:143]
    v_mfma_f32_16x16x32_bf16 v[80:83], v[176:179], v[192:195], v[80:83]
    ds_read_b128 v[208:211], v13 offset:2048
    v_mfma_f32_16x16x32_bf16 v[112:115], v[176:179], v[196:199], v[112:115]
    ds_read_b128 v[212:215], v13 offset:4096
    v_mfma_f32_16x16x32_bf16 v[144:147], v[200:203], v[176:179], v[144:147]
    v_mfma_f32_16x16x32_bf16 v[84:87], v[180:183], v[192:195], v[84:87]
    ds_read_b128 v[216:219], v13 offset:6144
    v_mfma_f32_16x16x32_bf16 v[116:119], v[180:183], v[196:199], v[116:119]
    v_mfma_f32_16x16x32_bf16 v[148:151], v[200:203], v[180:183], v[148:151]
    ds_read_b128 v[220:223], v13 offset:8192
    v_mfma_f32_16x16x32_bf16 v[88:91], v[184:187], v[192:195], v[88:91]
    ds_read_b128 v[224:227], v13 offset:10240
    v_mfma_f32_16x16x32_bf16 v[120:123], v[184:187], v[196:199], v[120:123]
    v_mfma_f32_16x16x32_bf16 v[152:155], v[200:203], v[184:187], v[152:155]
    ds_read_b128 v[228:231], v13 offset:12288
    v_mfma_f32_16x16x32_bf16 v[92:95], v[188:191], v[192:195], v[92:95]
    v_mfma_f32_16x16x32_bf16 v[124:127], v[188:191], v[196:199], v[124:127]
    ds_read_b128 v[232:235], v13 offset:14336
    v_mfma_f32_16x16x32_bf16 v[156:159], v[200:203], v[188:191], v[156:159]
    s_barrier
    s_waitcnt lgkmcnt(0)
    v_mfma_f32_16x16x32_bf16 v[64:67], v[204:207], v[236:239], v[64:67]
    ds_read_b64_tr_b16 v[192:193], v22 offset:0
    v_mfma_f32_16x16x32_bf16 v[96:99], v[204:207], v[240:243], v[96:99]
    ds_read_b64_tr_b16 v[194:195], v22 offset:1024
    v_mfma_f32_16x16x32_bf16 v[128:131], v[244:247], v[204:207], v[128:131]
    v_mfma_f32_16x16x32_bf16 v[68:71], v[208:211], v[236:239], v[68:71]
    ds_read_b64_tr_b16 v[196:197], v23 offset:0
    v_mfma_f32_16x16x32_bf16 v[100:103], v[208:211], v[240:243], v[100:103]
    v_mfma_f32_16x16x32_bf16 v[132:135], v[244:247], v[208:211], v[132:135]
    ds_read_b64_tr_b16 v[198:199], v23 offset:1024
    v_mfma_f32_16x16x32_bf16 v[72:75], v[212:215], v[236:239], v[72:75]
    ds_read_b64_tr_b16 v[200:201], v27 offset:0
    v_mfma_f32_16x16x32_bf16 v[104:107], v[212:215], v[240:243], v[104:107]
    v_mfma_f32_16x16x32_bf16 v[136:139], v[244:247], v[212:215], v[136:139]
    ds_read_b64_tr_b16 v[202:203], v27 offset:512
    v_mfma_f32_16x16x32_bf16 v[76:79], v[216:219], v[236:239], v[76:79]
    v_mfma_f32_16x16x32_bf16 v[108:111], v[216:219], v[240:243], v[108:111]
    ds_read_b128 v[160:163], v14 offset:0
    v_mfma_f32_16x16x32_bf16 v[140:143], v[244:247], v[216:219], v[140:143]
    v_mfma_f32_16x16x32_bf16 v[80:83], v[220:223], v[236:239], v[80:83]
    ds_read_b128 v[164:167], v14 offset:2048
    v_mfma_f32_16x16x32_bf16 v[112:115], v[220:223], v[240:243], v[112:115]
    ds_read_b128 v[168:171], v14 offset:4096
    v_mfma_f32_16x16x32_bf16 v[144:147], v[244:247], v[220:223], v[144:147]
    v_mfma_f32_16x16x32_bf16 v[84:87], v[224:227], v[236:239], v[84:87]
    ds_read_b128 v[172:175], v14 offset:6144
    v_mfma_f32_16x16x32_bf16 v[116:119], v[224:227], v[240:243], v[116:119]
    v_mfma_f32_16x16x32_bf16 v[148:151], v[244:247], v[224:227], v[148:151]
    ds_read_b128 v[176:179], v14 offset:8192
    v_mfma_f32_16x16x32_bf16 v[88:91], v[228:231], v[236:239], v[88:91]
    ds_read_b128 v[180:183], v14 offset:10240
    v_mfma_f32_16x16x32_bf16 v[120:123], v[228:231], v[240:243], v[120:123]
    v_mfma_f32_16x16x32_bf16 v[152:155], v[244:247], v[228:231], v[152:155]
    ds_read_b128 v[184:187], v14 offset:12288
    v_mfma_f32_16x16x32_bf16 v[92:95], v[232:235], v[236:239], v[92:95]
    v_mfma_f32_16x16x32_bf16 v[124:127], v[232:235], v[240:243], v[124:127]
    ds_read_b128 v[188:191], v14 offset:14336
    v_mfma_f32_16x16x32_bf16 v[156:159], v[244:247], v[232:235], v[156:159]
    s_waitcnt lgkmcnt(0)
    v_mfma_f32_16x16x32_bf16 v[64:67], v[160:163], v[192:195], v[64:67]
    ds_read_b64_tr_b16 v[236:237], v22 offset:8192
    v_mfma_f32_16x16x32_bf16 v[96:99], v[160:163], v[196:199], v[96:99]
    ds_read_b64_tr_b16 v[238:239], v22 offset:9216
    v_mfma_f32_16x16x32_bf16 v[128:131], v[200:203], v[160:163], v[128:131]
    v_mfma_f32_16x16x32_bf16 v[68:71], v[164:167], v[192:195], v[68:71]
    ds_read_b64_tr_b16 v[240:241], v23 offset:8192
    v_mfma_f32_16x16x32_bf16 v[100:103], v[164:167], v[196:199], v[100:103]
    v_mfma_f32_16x16x32_bf16 v[132:135], v[200:203], v[164:167], v[132:135]
    ds_read_b64_tr_b16 v[242:243], v23 offset:9216
    v_mfma_f32_16x16x32_bf16 v[72:75], v[168:171], v[192:195], v[72:75]
    ds_read_b64_tr_b16 v[244:245], v27 offset:4096
    v_mfma_f32_16x16x32_bf16 v[104:107], v[168:171], v[196:199], v[104:107]
    v_mfma_f32_16x16x32_bf16 v[136:139], v[200:203], v[168:171], v[136:139]
    ds_read_b64_tr_b16 v[246:247], v27 offset:4608
    v_mfma_f32_16x16x32_bf16 v[76:79], v[172:175], v[192:195], v[76:79]
    v_mfma_f32_16x16x32_bf16 v[108:111], v[172:175], v[196:199], v[108:111]
    ds_read_b128 v[204:207], v15 offset:0
    v_mfma_f32_16x16x32_bf16 v[140:143], v[200:203], v[172:175], v[140:143]
    v_mfma_f32_16x16x32_bf16 v[80:83], v[176:179], v[192:195], v[80:83]
    ds_read_b128 v[208:211], v15 offset:2048
    v_mfma_f32_16x16x32_bf16 v[112:115], v[176:179], v[196:199], v[112:115]
    ds_read_b128 v[212:215], v15 offset:4096
    v_mfma_f32_16x16x32_bf16 v[144:147], v[200:203], v[176:179], v[144:147]
    v_mfma_f32_16x16x32_bf16 v[84:87], v[180:183], v[192:195], v[84:87]
    ds_read_b128 v[216:219], v15 offset:6144
    v_mfma_f32_16x16x32_bf16 v[116:119], v[180:183], v[196:199], v[116:119]
    v_mfma_f32_16x16x32_bf16 v[148:151], v[200:203], v[180:183], v[148:151]
    ds_read_b128 v[220:223], v15 offset:8192
    v_mfma_f32_16x16x32_bf16 v[88:91], v[184:187], v[192:195], v[88:91]
    ds_read_b128 v[224:227], v15 offset:10240
    v_mfma_f32_16x16x32_bf16 v[120:123], v[184:187], v[196:199], v[120:123]
    v_mfma_f32_16x16x32_bf16 v[152:155], v[200:203], v[184:187], v[152:155]
    ds_read_b128 v[228:231], v15 offset:12288
    v_mfma_f32_16x16x32_bf16 v[92:95], v[188:191], v[192:195], v[92:95]
    v_mfma_f32_16x16x32_bf16 v[124:127], v[188:191], v[196:199], v[124:127]
    ds_read_b128 v[232:235], v15 offset:14336
    v_mfma_f32_16x16x32_bf16 v[156:159], v[200:203], v[188:191], v[156:159]
    s_mov_b64 exec, 1
    buffer_load_dwordx2 v[30:31], v32, s[20:23], s55 offen sc1
    s_mov_b64 exec, -1
    s_waitcnt lgkmcnt(0)
    s_barrier
    v_mfma_f32_16x16x32_bf16 v[64:67], v[204:207], v[236:239], v[64:67]
    v_mfma_f32_16x16x32_bf16 v[96:99], v[204:207], v[240:243], v[96:99]
    v_mfma_f32_16x16x32_bf16 v[128:131], v[244:247], v[204:207], v[128:131]
    v_mfma_f32_16x16x32_bf16 v[68:71], v[208:211], v[236:239], v[68:71]
    v_mfma_f32_16x16x32_bf16 v[100:103], v[208:211], v[240:243], v[100:103]
    v_mfma_f32_16x16x32_bf16 v[132:135], v[244:247], v[208:211], v[132:135]
    v_mfma_f32_16x16x32_bf16 v[72:75], v[212:215], v[236:239], v[72:75]
    v_mfma_f32_16x16x32_bf16 v[104:107], v[212:215], v[240:243], v[104:107]
    v_mfma_f32_16x16x32_bf16 v[136:139], v[244:247], v[212:215], v[136:139]
    v_mfma_f32_16x16x32_bf16 v[76:79], v[216:219], v[236:239], v[76:79]
    v_mfma_f32_16x16x32_bf16 v[108:111], v[216:219], v[240:243], v[108:111]
    v_mfma_f32_16x16x32_bf16 v[140:143], v[244:247], v[216:219], v[140:143]
    v_mfma_f32_16x16x32_bf16 v[80:83], v[220:223], v[236:239], v[80:83]
    v_mfma_f32_16x16x32_bf16 v[112:115], v[220:223], v[240:243], v[112:115]
    v_mfma_f32_16x16x32_bf16 v[144:147], v[244:247], v[220:223], v[144:147]
    v_mfma_f32_16x16x32_bf16 v[84:87], v[224:227], v[236:239], v[84:87]
    v_mfma_f32_16x16x32_bf16 v[116:119], v[224:227], v[240:243], v[116:119]
    v_mfma_f32_16x16x32_bf16 v[148:151], v[244:247], v[224:227], v[148:151]
    v_mfma_f32_16x16x32_bf16 v[88:91], v[228:231], v[236:239], v[88:91]
    v_mfma_f32_16x16x32_bf16 v[120:123], v[228:231], v[240:243], v[120:123]
    v_mfma_f32_16x16x32_bf16 v[152:155], v[244:247], v[228:231], v[152:155]
    v_mfma_f32_16x16x32_bf16 v[92:95], v[232:235], v[236:239], v[92:95]
    v_mfma_f32_16x16x32_bf16 v[124:127], v[232:235], v[240:243], v[124:127]
    v_mfma_f32_16x16x32_bf16 v[156:159], v[244:247], v[232:235], v[156:159]
    s_nop 9
    s_lshl_b32 s49, s5, 2
    s_add_u32 s49, s49, s3
    v_cvt_pk_bf16_f32 v52, v64, v65
    v_lshlrev_b32 v64, 16, v52
    v_and_b32 v65, 0xffff0000, v52
    v_mul_f32 v53, s50, v64
    v_mul_f32 v54, s50, v65
    v_exp_f32 v53, v53
    v_exp_f32 v54, v54
    v_cmp_lt_f32 vcc, 0, v64
    v_cmp_lt_f32 s[52:53], 0, v65
    v_add_f32 v55, 1.0, v64
    v_add_f32 v56, 1.0, v65
    v_cndmask_b32 v64, v53, v55, vcc
    v_cndmask_b32 v65, v54, v56, s[52:53]
    v_cvt_pk_bf16_f32 v52, v64, v65
    v_lshlrev_b32 v64, 16, v52
    v_and_b32 v65, 0xffff0000, v52
    v_add_f32 v64, s51, v64
    v_add_f32 v65, s51, v65
    v_cvt_pk_bf16_f32 v160, v64, v65
    v_cvt_pk_bf16_f32 v176, v96, v97
    v_cvt_pk_bf16_f32 v52, v66, v67
    v_lshlrev_b32 v66, 16, v52
    v_and_b32 v67, 0xffff0000, v52
    v_mul_f32 v53, s50, v66
    v_mul_f32 v54, s50, v67
    v_exp_f32 v53, v53
    v_exp_f32 v54, v54
    v_cmp_lt_f32 vcc, 0, v66
    v_cmp_lt_f32 s[52:53], 0, v67
    v_add_f32 v55, 1.0, v66
    v_add_f32 v56, 1.0, v67
    v_cndmask_b32 v66, v53, v55, vcc
    v_cndmask_b32 v67, v54, v56, s[52:53]
    v_cvt_pk_bf16_f32 v52, v66, v67
    v_lshlrev_b32 v66, 16, v52
    v_and_b32 v67, 0xffff0000, v52
    v_add_f32 v66, s51, v66
    v_add_f32 v67, s51, v67
    v_cvt_pk_bf16_f32 v161, v66, v67
    v_cvt_pk_bf16_f32 v177, v98, v99
    v_cvt_pk_bf16_f32 v52, v68, v69
    v_lshlrev_b32 v68, 16, v52
    v_and_b32 v69, 0xffff0000, v52
    v_mul_f32 v53, s50, v68
    v_mul_f32 v54, s50, v69
    v_exp_f32 v53, v53
    v_exp_f32 v54, v54
    v_cmp_lt_f32 vcc, 0, v68
    v_cmp_lt_f32 s[52:53], 0, v69
    v_add_f32 v55, 1.0, v68
    v_add_f32 v56, 1.0, v69
    v_cndmask_b32 v68, v53, v55, vcc
    v_cndmask_b32 v69, v54, v56, s[52:53]
    v_cvt_pk_bf16_f32 v52, v68, v69
    v_lshlrev_b32 v68, 16, v52
    v_and_b32 v69, 0xffff0000, v52
    v_add_f32 v68, s51, v68
    v_add_f32 v69, s51, v69
    v_cvt_pk_bf16_f32 v162, v68, v69
    v_cvt_pk_bf16_f32 v178, v100, v101
    v_cvt_pk_bf16_f32 v52, v70, v71
    v_lshlrev_b32 v70, 16, v52
    v_and_b32 v71, 0xffff0000, v52
    v_mul_f32 v53, s50, v70
    v_mul_f32 v54, s50, v71
    v_exp_f32 v53, v53
    v_exp_f32 v54, v54
    v_cmp_lt_f32 vcc, 0, v70
    v_cmp_lt_f32 s[52:53], 0, v71
    v_add_f32 v55, 1.0, v70
    v_add_f32 v56, 1.0, v71
    v_cndmask_b32 v70, v53, v55, vcc
    v_cndmask_b32 v71, v54, v56, s[52:53]
    v_cvt_pk_bf16_f32 v52, v70, v71
    v_lshlrev_b32 v70, 16, v52
    v_and_b32 v71, 0xffff0000, v52
    v_add_f32 v70, s51, v70
    v_add_f32 v71, s51, v71
    v_cvt_pk_bf16_f32 v163, v70, v71
    v_cvt_pk_bf16_f32 v179, v102, v103
    v_cvt_pk_bf16_f32 v52, v72, v73
    v_lshlrev_b32 v72, 16, v52
    v_and_b32 v73, 0xffff0000, v52
    v_mul_f32 v53, s50, v72
    v_mul_f32 v54, s50, v73
    v_exp_f32 v53, v53
    v_exp_f32 v54, v54
    v_cmp_lt_f32 vcc, 0, v72
    v_cmp_lt_f32 s[52:53], 0, v73
    v_add_f32 v55, 1.0, v72
    v_add_f32 v56, 1.0, v73
    v_cndmask_b32 v72, v53, v55, vcc
    v_cndmask_b32 v73, v54, v56, s[52:53]
    v_cvt_pk_bf16_f32 v52, v72, v73
    v_lshlrev_b32 v72, 16, v52
    v_and_b32 v73, 0xffff0000, v52
    v_add_f32 v72, s51, v72
    v_add_f32 v73, s51, v73
    v_cvt_pk_bf16_f32 v164, v72, v73
    v_cvt_pk_bf16_f32 v180, v104, v105
    v_cvt_pk_bf16_f32 v52, v74, v75
    v_lshlrev_b32 v74, 16, v52
    v_and_b32 v75, 0xffff0000, v52
    v_mul_f32 v53, s50, v74
    v_mul_f32 v54, s50, v75
    v_exp_f32 v53, v53
    v_exp_f32 v54, v54
    v_cmp_lt_f32 vcc, 0, v74
    v_cmp_lt_f32 s[52:53], 0, v75
    v_add_f32 v55, 1.0, v74
    v_add_f32 v56, 1.0, v75
    v_cndmask_b32 v74, v53, v55, vcc
    v_cndmask_b32 v75, v54, v56, s[52:53]
    v_cvt_pk_bf16_f32 v52, v74, v75
    v_lshlrev_b32 v74, 16, v52
    v_and_b32 v75, 0xffff0000, v52
    v_add_f32 v74, s51, v74
    v_add_f32 v75, s51, v75
    v_cvt_pk_bf16_f32 v165, v74, v75
    v_cvt_pk_bf16_f32 v181, v106, v107
    v_cvt_pk_bf16_f32 v52, v76, v77
    v_lshlrev_b32 v76, 16, v52
    v_and_b32 v77, 0xffff0000, v52
    v_mul_f32 v53, s50, v76
    v_mul_f32 v54, s50, v77
    v_exp_f32 v53, v53
    v_exp_f32 v54, v54
    v_cmp_lt_f32 vcc, 0, v76
    v_cmp_lt_f32 s[52:53], 0, v77
    v_add_f32 v55, 1.0, v76
    v_add_f32 v56, 1.0, v77
    v_cndmask_b32 v76, v53, v55, vcc
    v_cndmask_b32 v77, v54, v56, s[52:53]
    v_cvt_pk_bf16_f32 v52, v76, v77
    v_lshlrev_b32 v76, 16, v52
    v_and_b32 v77, 0xffff0000, v52
    v_add_f32 v76, s51, v76
    v_add_f32 v77, s51, v77
    v_cvt_pk_bf16_f32 v166, v76, v77
    v_cvt_pk_bf16_f32 v182, v108, v109
    v_cvt_pk_bf16_f32 v52, v78, v79
    v_lshlrev_b32 v78, 16, v52
    v_and_b32 v79, 0xffff0000, v52
    v_mul_f32 v53, s50, v78
    v_mul_f32 v54, s50, v79
    v_exp_f32 v53, v53
    v_exp_f32 v54, v54
    v_cmp_lt_f32 vcc, 0, v78
    v_cmp_lt_f32 s[52:53], 0, v79
    v_add_f32 v55, 1.0, v78
    v_add_f32 v56, 1.0, v79
    v_cndmask_b32 v78, v53, v55, vcc
    v_cndmask_b32 v79, v54, v56, s[52:53]
    v_cvt_pk_bf16_f32 v52, v78, v79
    v_lshlrev_b32 v78, 16, v52
    v_and_b32 v79, 0xffff0000, v52
    v_add_f32 v78, s51, v78
    v_add_f32 v79, s51, v79
    v_cvt_pk_bf16_f32 v167, v78, v79
    v_cvt_pk_bf16_f32 v183, v110, v111
    v_cvt_pk_bf16_f32 v52, v80, v81
    v_lshlrev_b32 v80, 16, v52
    v_and_b32 v81, 0xffff0000, v52
    v_mul_f32 v53, s50, v80
    v_mul_f32 v54, s50, v81
    v_exp_f32 v53, v53
    v_exp_f32 v54, v54
    v_cmp_lt_f32 vcc, 0, v80
    v_cmp_lt_f32 s[52:53], 0, v81
    v_add_f32 v55, 1.0, v80
    v_add_f32 v56, 1.0, v81
    v_cndmask_b32 v80, v53, v55, vcc
    v_cndmask_b32 v81, v54, v56, s[52:53]
    v_cvt_pk_bf16_f32 v52, v80, v81
    v_lshlrev_b32 v80, 16, v52
    v_and_b32 v81, 0xffff0000, v52
    v_add_f32 v80, s51, v80
    v_add_f32 v81, s51, v81
    v_cvt_pk_bf16_f32 v168, v80, v81
    v_cvt_pk_bf16_f32 v184, v112, v113
    v_cvt_pk_bf16_f32 v52, v82, v83
    v_lshlrev_b32 v82, 16, v52
    v_and_b32 v83, 0xffff0000, v52
    v_mul_f32 v53, s50, v82
    v_mul_f32 v54, s50, v83
    v_exp_f32 v53, v53
    v_exp_f32 v54, v54
    v_cmp_lt_f32 vcc, 0, v82
    v_cmp_lt_f32 s[52:53], 0, v83
    v_add_f32 v55, 1.0, v82
    v_add_f32 v56, 1.0, v83
    v_cndmask_b32 v82, v53, v55, vcc
    v_cndmask_b32 v83, v54, v56, s[52:53]
    v_cvt_pk_bf16_f32 v52, v82, v83
    v_lshlrev_b32 v82, 16, v52
    v_and_b32 v83, 0xffff0000, v52
    v_add_f32 v82, s51, v82
    v_add_f32 v83, s51, v83
    v_cvt_pk_bf16_f32 v169, v82, v83
    v_cvt_pk_bf16_f32 v185, v114, v115
    v_cvt_pk_bf16_f32 v52, v84, v85
    v_lshlrev_b32 v84, 16, v52
    v_and_b32 v85, 0xffff0000, v52
    v_mul_f32 v53, s50, v84
    v_mul_f32 v54, s50, v85
    v_exp_f32 v53, v53
    v_exp_f32 v54, v54
    v_cmp_lt_f32 vcc, 0, v84
    v_cmp_lt_f32 s[52:53], 0, v85
    v_add_f32 v55, 1.0, v84
    v_add_f32 v56, 1.0, v85
    v_cndmask_b32 v84, v53, v55, vcc
    v_cndmask_b32 v85, v54, v56, s[52:53]
    v_cvt_pk_bf16_f32 v52, v84, v85
    v_lshlrev_b32 v84, 16, v52
    v_and_b32 v85, 0xffff0000, v52
    v_add_f32 v84, s51, v84
    v_add_f32 v85, s51, v85
    v_cvt_pk_bf16_f32 v170, v84, v85
    v_cvt_pk_bf16_f32 v186, v116, v117
    v_cvt_pk_bf16_f32 v52, v86, v87
    v_lshlrev_b32 v86, 16, v52
    v_and_b32 v87, 0xffff0000, v52
    v_mul_f32 v53, s50, v86
    v_mul_f32 v54, s50, v87
    v_exp_f32 v53, v53
    v_exp_f32 v54, v54
    v_cmp_lt_f32 vcc, 0, v86
    v_cmp_lt_f32 s[52:53], 0, v87
    v_add_f32 v55, 1.0, v86
    v_add_f32 v56, 1.0, v87
    v_cndmask_b32 v86, v53, v55, vcc
    v_cndmask_b32 v87, v54, v56, s[52:53]
    v_cvt_pk_bf16_f32 v52, v86, v87
    v_lshlrev_b32 v86, 16, v52
    v_and_b32 v87, 0xffff0000, v52
    v_add_f32 v86, s51, v86
    v_add_f32 v87, s51, v87
    v_cvt_pk_bf16_f32 v171, v86, v87
    v_cvt_pk_bf16_f32 v187, v118, v119
    v_cvt_pk_bf16_f32 v52, v88, v89
    v_lshlrev_b32 v88, 16, v52
    v_and_b32 v89, 0xffff0000, v52
    v_mul_f32 v53, s50, v88
    v_mul_f32 v54, s50, v89
    v_exp_f32 v53, v53
    v_exp_f32 v54, v54
    v_cmp_lt_f32 vcc, 0, v88
    v_cmp_lt_f32 s[52:53], 0, v89
    v_add_f32 v55, 1.0, v88
    v_add_f32 v56, 1.0, v89
    v_cndmask_b32 v88, v53, v55, vcc
    v_cndmask_b32 v89, v54, v56, s[52:53]
    v_cvt_pk_bf16_f32 v52, v88, v89
    v_lshlrev_b32 v88, 16, v52
    v_and_b32 v89, 0xffff0000, v52
    v_add_f32 v88, s51, v88
    v_add_f32 v89, s51, v89
    v_cvt_pk_bf16_f32 v172, v88, v89
    v_cvt_pk_bf16_f32 v188, v120, v121
    v_cvt_pk_bf16_f32 v52, v90, v91
    v_lshlrev_b32 v90, 16, v52
    v_and_b32 v91, 0xffff0000, v52
    v_mul_f32 v53, s50, v90
    v_mul_f32 v54, s50, v91
    v_exp_f32 v53, v53
    v_exp_f32 v54, v54
    v_cmp_lt_f32 vcc, 0, v90
    v_cmp_lt_f32 s[52:53], 0, v91
    v_add_f32 v55, 1.0, v90
    v_add_f32 v56, 1.0, v91
    v_cndmask_b32 v90, v53, v55, vcc
    v_cndmask_b32 v91, v54, v56, s[52:53]
    v_cvt_pk_bf16_f32 v52, v90, v91
    v_lshlrev_b32 v90, 16, v52
    v_and_b32 v91, 0xffff0000, v52
    v_add_f32 v90, s51, v90
    v_add_f32 v91, s51, v91
    v_cvt_pk_bf16_f32 v173, v90, v91
    v_cvt_pk_bf16_f32 v189, v122, v123
    v_cvt_pk_bf16_f32 v52, v92, v93
    v_lshlrev_b32 v92, 16, v52
    v_and_b32 v93, 0xffff0000, v52
    v_mul_f32 v53, s50, v92
    v_mul_f32 v54, s50, v93
    v_exp_f32 v53, v53
    v_exp_f32 v54, v54
    v_cmp_lt_f32 vcc, 0, v92
    v_cmp_lt_f32 s[52:53], 0, v93
    v_add_f32 v55, 1.0, v92
    v_add_f32 v56, 1.0, v93
    v_cndmask_b32 v92, v53, v55, vcc
    v_cndmask_b32 v93, v54, v56, s[52:53]
    v_cvt_pk_bf16_f32 v52, v92, v93
    v_lshlrev_b32 v92, 16, v52
    v_and_b32 v93, 0xffff0000, v52
    v_add_f32 v92, s51, v92
    v_add_f32 v93, s51, v93
    v_cvt_pk_bf16_f32 v174, v92, v93
    v_cvt_pk_bf16_f32 v190, v124, v125
    v_cvt_pk_bf16_f32 v52, v94, v95
    v_lshlrev_b32 v94, 16, v52
    v_and_b32 v95, 0xffff0000, v52
    v_mul_f32 v53, s50, v94
    v_mul_f32 v54, s50, v95
    v_exp_f32 v53, v53
    v_exp_f32 v54, v54
    v_cmp_lt_f32 vcc, 0, v94
    v_cmp_lt_f32 s[52:53], 0, v95
    v_add_f32 v55, 1.0, v94
    v_add_f32 v56, 1.0, v95
    v_cndmask_b32 v94, v53, v55, vcc
    v_cndmask_b32 v95, v54, v56, s[52:53]
    v_cvt_pk_bf16_f32 v52, v94, v95
    v_lshlrev_b32 v94, 16, v52
    v_and_b32 v95, 0xffff0000, v52
    v_add_f32 v94, s51, v94
    v_add_f32 v95, s51, v95
    v_cvt_pk_bf16_f32 v175, v94, v95
    v_cvt_pk_bf16_f32 v191, v126, v127
    v_mov_b32 v40, 0x3f803f80
    v_mov_b32 v41, 0x3f803f80
    v_mov_b32 v42, 0x3f803f80
    v_mov_b32 v43, 0x3f803f80
    s_nop 1
    v_mfma_f32_16x16x32_bf16 v[44:47], v[160:163], v[176:179], 0
    v_mfma_f32_16x16x32_bf16 v[48:51], v[160:163], v[40:43], 0
    v_mfma_f32_16x16x32_bf16 v[44:47], v[164:167], v[180:183], v[44:47]
    v_mfma_f32_16x16x32_bf16 v[48:51], v[164:167], v[40:43], v[48:51]
    v_mfma_f32_16x16x32_bf16 v[44:47], v[168:171], v[184:187], v[44:47]
    v_mfma_f32_16x16x32_bf16 v[48:51], v[168:171], v[40:43], v[48:51]
    v_mfma_f32_16x16x32_bf16 v[44:47], v[172:175], v[188:191], v[44:47]
    v_mfma_f32_16x16x32_bf16 v[48:51], v[172:175], v[40:43], v[48:51]
    v_lshlrev_b32 v5, 2, v2
    v_lshl_add_u32 v6, v3, 2, v4
    v_lshlrev_b32 v6, 2, v6
    v_lshlrev_b32 v7, 4, v2
    s_mov_b32 s47, 0
    s_branch ATC1
ATC0:
    s_sleep 2
    s_mov_b64 exec, 1
    buffer_load_dwordx2 v[30:31], v32, s[20:23], s55 offen sc1
    s_mov_b64 exec, -1
ATC1:
    s_waitcnt vmcnt(0)
    v_readfirstlane_b32 s42, v30
    v_readfirstlane_b32 s43, v31
    s_add_u32 s47, s47, 1
    s_cmp_ge_u32 s47, 0x40000
    s_cbranch_scc1 ATC2
    s_cmp_eq_u64 s[42:43], s[40:41]
    s_cbranch_scc0 ATC0
ATC2:
    s_mov_b32 s42, 0x00020002
    s_mov_b32 s43, 0x00020002
    s_mov_b32 s44, 0x00040004
    s_mov_b32 s45, 0x00040004
    s_mov_b32 s52, 0x00080008
    s_mov_b32 s53, 0x00080008
    s_nop 3
    buffer_atomic_add_f32 v44, v5, s[20:23], s54 offen offset:0 sc1
    buffer_atomic_add_f32 v45, v5, s[20:23], s54 offen offset:256 sc1
    buffer_atomic_add_f32 v46, v5, s[20:23], s54 offen offset:512 sc1
    buffer_atomic_add_f32 v47, v5, s[20:23], s54 offen offset:768 sc1
    v_cndmask_b32 v40, v48, v49, s[42:43]
    v_cndmask_b32 v40, v40, v50, s[44:45]
    v_cndmask_b32 v40, v40, v51, s[52:53]
    s_mov_b32 s42, 0x000f000f
    s_mov_b32 s43, 0x000f000f
    s_mov_b64 exec, s[42:43]
    buffer_atomic_add_f32 v40, v6, s[20:23], s54 offen offset:1024 sc1
    s_mov_b64 exec, -1
    s_lshl_b32 s42, s4, 17
    s_lshl_b32 s43, s49, 11
    s_add_u32 s48, s42, s43
    s_add_u32 s48, s48, 0xc00000
    s_add_u32 s55, s48, 65536
    s_mul_i32 s42, s5, 4352
    s_lshl_b32 s43, s4, 2
    s_add_u32 s43, s43, s3
    s_lshl_b32 s43, s43, 3
    s_add_u32 s42, s42, s43
    s_add_u32 s54, s42, 0x300000
    v_mul_u32_u24 v33, 34816, v2
    v_cvt_pk_bf16_f32 v52, v128, v129
    v_lshlrev_b32 v128, 16, v52
    v_and_b32 v129, 0xffff0000, v52
    v_mul_f32 v53, s50, v128
    v_mul_f32 v54, s50, v129
    v_exp_f32 v53, v53
    v_exp_f32 v54, v54
    v_cmp_lt_f32 vcc, 0, v128
    v_cmp_lt_f32 s[52:53], 0, v129
    v_add_f32 v55, 1.0, v128
    v_add_f32 v56, 1.0, v129
    v_cndmask_b32 v128, v53, v55, vcc
    v_cndmask_b32 v129, v54, v56, s[52:53]
    v_cvt_pk_bf16_f32 v52, v128, v129
    v_lshlrev_b32 v128, 16, v52
    v_and_b32 v129, 0xffff0000, v52
    v_add_f32 v128, s51, v128
    v_add_f32 v129, s51, v129
    v_cvt_pk_bf16_f32 v64, v128, v129
    v_cvt_pk_bf16_f32 v52, v130, v131
    v_lshlrev_b32 v130, 16, v52
    v_and_b32 v131, 0xffff0000, v52
    v_mul_f32 v53, s50, v130
    v_mul_f32 v54, s50, v131
    v_exp_f32 v53, v53
    v_exp_f32 v54, v54
    v_cmp_lt_f32 vcc, 0, v130
    v_cmp_lt_f32 s[52:53], 0, v131
    v_add_f32 v55, 1.0, v130
    v_add_f32 v56, 1.0, v131
    v_cndmask_b32 v130, v53, v55, vcc
    v_cndmask_b32 v131, v54, v56, s[52:53]
    v_cvt_pk_bf16_f32 v52, v130, v131
    v_lshlrev_b32 v130, 16, v52
    v_and_b32 v131, 0xffff0000, v52
    v_add_f32 v130, s51, v130
    v_add_f32 v131, s51, v131
    v_cvt_pk_bf16_f32 v65, v130, v131
    v_cvt_pk_bf16_f32 v52, v132, v133
    v_lshlrev_b32 v132, 16, v52
    v_and_b32 v133, 0xffff0000, v52
    v_mul_f32 v53, s50, v132
    v_mul_f32 v54, s50, v133
    v_exp_f32 v53, v53
    v_exp_f32 v54, v54
    v_cmp_lt_f32 vcc, 0, v132
    v_cmp_lt_f32 s[52:53], 0, v133
    v_add_f32 v55, 1.0, v132
    v_add_f32 v56, 1.0, v133
    v_cndmask_b32 v132, v53, v55, vcc
    v_cndmask_b32 v133, v54, v56, s[52:53]
    v_cvt_pk_bf16_f32 v52, v132, v133
    v_lshlrev_b32 v132, 16, v52
    v_and_b32 v133, 0xffff0000, v52
    v_add_f32 v132, s51, v132
    v_add_f32 v133, s51, v133
    v_cvt_pk_bf16_f32 v66, v132, v133
    v_cvt_pk_bf16_f32 v52, v134, v135
    v_lshlrev_b32 v134, 16, v52
    v_and_b32 v135, 0xffff0000, v52
    v_mul_f32 v53, s50, v134
    v_mul_f32 v54, s50, v135
    v_exp_f32 v53, v53
    v_exp_f32 v54, v54
    v_cmp_lt_f32 vcc, 0, v134
    v_cmp_lt_f32 s[52:53], 0, v135
    v_add_f32 v55, 1.0, v134
    v_add_f32 v56, 1.0, v135
    v_cndmask_b32 v134, v53, v55, vcc
    v_cndmask_b32 v135, v54, v56, s[52:53]
    v_cvt_pk_bf16_f32 v52, v134, v135
    v_lshlrev_b32 v134, 16, v52
    v_and_b32 v135, 0xffff0000, v52
    v_add_f32 v134, s51, v134
    v_add_f32 v135, s51, v135
    v_cvt_pk_bf16_f32 v67, v134, v135
    buffer_store_dwordx4 v[64:67], v7, s[20:23], s48 offen offset:0 sc1
    v_cvt_pk_bf16_f32 v52, v136, v137
    v_lshlrev_b32 v136, 16, v52
    v_and_b32 v137, 0xffff0000, v52
    v_mul_f32 v53, s50, v136
    v_mul_f32 v54, s50, v137
    v_exp_f32 v53, v53
    v_exp_f32 v54, v54
    v_cmp_lt_f32 vcc, 0, v136
    v_cmp_lt_f32 s[52:53], 0, v137
    v_add_f32 v55, 1.0, v136
    v_add_f32 v56, 1.0, v137
    v_cndmask_b32 v136, v53, v55, vcc
    v_cndmask_b32 v137, v54, v56, s[52:53]
    v_cvt_pk_bf16_f32 v52, v136, v137
    v_lshlrev_b32 v136, 16, v52
    v_and_b32 v137, 0xffff0000, v52
    v_add_f32 v136, s51, v136
    v_add_f32 v137, s51, v137
    v_cvt_pk_bf16_f32 v68, v136, v137
    v_cvt_pk_bf16_f32 v52, v138, v139
    v_lshlrev_b32 v138, 16, v52
    v_and_b32 v139, 0xffff0000, v52
    v_mul_f32 v53, s50, v138
    v_mul_f32 v54, s50, v139
    v_exp_f32 v53, v53
    v_exp_f32 v54, v54
    v_cmp_lt_f32 vcc, 0, v138
    v_cmp_lt_f32 s[52:53], 0, v139
    v_add_f32 v55, 1.0, v138
    v_add_f32 v56, 1.0, v139
    v_cndmask_b32 v138, v53, v55, vcc
    v_cndmask_b32 v139, v54, v56, s[52:53]
    v_cvt_pk_bf16_f32 v52, v138, v139
    v_lshlrev_b32 v138, 16, v52
    v_and_b32 v139, 0xffff0000, v52
    v_add_f32 v138, s51, v138
    v_add_f32 v139, s51, v139
    v_cvt_pk_bf16_f32 v69, v138, v139
    v_cvt_pk_bf16_f32 v52, v140, v141
    v_lshlrev_b32 v140, 16, v52
    v_and_b32 v141, 0xffff0000, v52
    v_mul_f32 v53, s50, v140
    v_mul_f32 v54, s50, v141
    v_exp_f32 v53, v53
    v_exp_f32 v54, v54
    v_cmp_lt_f32 vcc, 0, v140
    v_cmp_lt_f32 s[52:53], 0, v141
    v_add_f32 v55, 1.0, v140
    v_add_f32 v56, 1.0, v141
    v_cndmask_b32 v140, v53, v55, vcc
    v_cndmask_b32 v141, v54, v56, s[52:53]
    v_cvt_pk_bf16_f32 v52, v140, v141
    v_lshlrev_b32 v140, 16, v52
    v_and_b32 v141, 0xffff0000, v52
    v_add_f32 v140, s51, v140
    v_add_f32 v141, s51, v141
    v_cvt_pk_bf16_f32 v70, v140, v141
    v_cvt_pk_bf16_f32 v52, v142, v143
    v_lshlrev_b32 v142, 16, v52
    v_and_b32 v143, 0xffff0000, v52
    v_mul_f32 v53, s50, v142
    v_mul_f32 v54, s50, v143
    v_exp_f32 v53, v53
    v_exp_f32 v54, v54
    v_cmp_lt_f32 vcc, 0, v142
    v_cmp_lt_f32 s[52:53], 0, v143
    v_add_f32 v55, 1.0, v142
    v_add_f32 v56, 1.0, v143
    v_cndmask_b32 v142, v53, v55, vcc
    v_cndmask_b32 v143, v54, v56, s[52:53]
    v_cvt_pk_bf16_f32 v52, v142, v143
    v_lshlrev_b32 v142, 16, v52
    v_and_b32 v143, 0xffff0000, v52
    v_add_f32 v142, s51, v142
    v_add_f32 v143, s51, v143
    v_cvt_pk_bf16_f32 v71, v142, v143
    buffer_store_dwordx4 v[68:71], v7, s[20:23], s48 offen offset:1024 sc1
    v_cvt_pk_bf16_f32 v52, v144, v145
    v_lshlrev_b32 v144, 16, v52
    v_and_b32 v145, 0xffff0000, v52
    v_mul_f32 v53, s50, v144
    v_mul_f32 v54, s50, v145
    v_exp_f32 v53, v53
    v_exp_f32 v54, v54
    v_cmp_lt_f32 vcc, 0, v144
    v_cmp_lt_f32 s[52:53], 0, v145
    v_add_f32 v55, 1.0, v144
    v_add_f32 v56, 1.0, v145
    v_cndmask_b32 v144, v53, v55, vcc
    v_cndmask_b32 v145, v54, v56, s[52:53]
    v_cvt_pk_bf16_f32 v52, v144, v145
    v_lshlrev_b32 v144, 16, v52
    v_and_b32 v145, 0xffff0000, v52
    v_add_f32 v144, s51, v144
    v_add_f32 v145, s51, v145
    v_cvt_pk_bf16_f32 v72, v144, v145
    v_cvt_pk_bf16_f32 v52, v146, v147
    v_lshlrev_b32 v146, 16, v52
    v_and_b32 v147, 0xffff0000, v52
    v_mul_f32 v53, s50, v146
    v_mul_f32 v54, s50, v147
    v_exp_f32 v53, v53
    v_exp_f32 v54, v54
    v_cmp_lt_f32 vcc, 0, v146
    v_cmp_lt_f32 s[52:53], 0, v147
    v_add_f32 v55, 1.0, v146
    v_add_f32 v56, 1.0, v147
    v_cndmask_b32 v146, v53, v55, vcc
    v_cndmask_b32 v147, v54, v56, s[52:53]
    v_cvt_pk_bf16_f32 v52, v146, v147
    v_lshlrev_b32 v146, 16, v52
    v_and_b32 v147, 0xffff0000, v52
    v_add_f32 v146, s51, v146
    v_add_f32 v147, s51, v147
    v_cvt_pk_bf16_f32 v73, v146, v147
    v_cvt_pk_bf16_f32 v52, v148, v149
    v_lshlrev_b32 v148, 16, v52
    v_and_b32 v149, 0xffff0000, v52
    v_mul_f32 v53, s50, v148
    v_mul_f32 v54, s50, v149
    v_exp_f32 v53, v53
    v_exp_f32 v54, v54
    v_cmp_lt_f32 vcc, 0, v148
    v_cmp_lt_f32 s[52:53], 0, v149
    v_add_f32 v55, 1.0, v148
    v_add_f32 v56, 1.0, v149
    v_cndmask_b32 v148, v53, v55, vcc
    v_cndmask_b32 v149, v54, v56, s[52:53]
    v_cvt_pk_bf16_f32 v52, v148, v149
    v_lshlrev_b32 v148, 16, v52
    v_and_b32 v149, 0xffff0000, v52
    v_add_f32 v148, s51, v148
    v_add_f32 v149, s51, v149
    v_cvt_pk_bf16_f32 v74, v148, v149
    v_cvt_pk_bf16_f32 v52, v150, v151
    v_lshlrev_b32 v150, 16, v52
    v_and_b32 v151, 0xffff0000, v52
    v_mul_f32 v53, s50, v150
    v_mul_f32 v54, s50, v151
    v_exp_f32 v53, v53
    v_exp_f32 v54, v54
    v_cmp_lt_f32 vcc, 0, v150
    v_cmp_lt_f32 s[52:53], 0, v151
    v_add_f32 v55, 1.0, v150
    v_add_f32 v56, 1.0, v151
    v_cndmask_b32 v150, v53, v55, vcc
    v_cndmask_b32 v151, v54, v56, s[52:53]
    v_cvt_pk_bf16_f32 v52, v150, v151
    v_lshlrev_b32 v150, 16, v52
    v_and_b32 v151, 0xffff0000, v52
    v_add_f32 v150, s51, v150
    v_add_f32 v151, s51, v151
    v_cvt_pk_bf16_f32 v75, v150, v151
    buffer_store_dwordx4 v[72:75], v7, s[20:23], s55 offen offset:0 sc1
    v_cvt_pk_bf16_f32 v52, v152, v153
    v_lshlrev_b32 v152, 16, v52
    v_and_b32 v153, 0xffff0000, v52
    v_mul_f32 v53, s50, v152
    v_mul_f32 v54, s50, v153
    v_exp_f32 v53, v53
    v_exp_f32 v54, v54
    v_cmp_lt_f32 vcc, 0, v152
    v_cmp_lt_f32 s[52:53], 0, v153
    v_add_f32 v55, 1.0, v152
    v_add_f32 v56, 1.0, v153
    v_cndmask_b32 v152, v53, v55, vcc
    v_cndmask_b32 v153, v54, v56, s[52:53]
    v_cvt_pk_bf16_f32 v52, v152, v153
    v_lshlrev_b32 v152, 16, v52
    v_and_b32 v153, 0xffff0000, v52
    v_add_f32 v152, s51, v152
    v_add_f32 v153, s51, v153
    v_cvt_pk_bf16_f32 v76, v152, v153
    v_cvt_pk_bf16_f32 v52, v154, v155
    v_lshlrev_b32 v154, 16, v52
    v_and_b32 v155, 0xffff0000, v52
    v_mul_f32 v53, s50, v154
    v_mul_f32 v54, s50, v155
    v_exp_f32 v53, v53
    v_exp_f32 v54, v54
    v_cmp_lt_f32 vcc, 0, v154
    v_cmp_lt_f32 s[52:53], 0, v155
    v_add_f32 v55, 1.0, v154
    v_add_f32 v56, 1.0, v155
    v_cndmask_b32 v154, v53, v55, vcc
    v_cndmask_b32 v155, v54, v56, s[52:53]
    v_cvt_pk_bf16_f32 v52, v154, v155
    v_lshlrev_b32 v154, 16, v52
    v_and_b32 v155, 0xffff0000, v52
    v_add_f32 v154, s51, v154
    v_add_f32 v155, s51, v155
    v_cvt_pk_bf16_f32 v77, v154, v155
    v_cvt_pk_bf16_f32 v52, v156, v157
    v_lshlrev_b32 v156, 16, v52
    v_and_b32 v157, 0xffff0000, v52
    v_mul_f32 v53, s50, v156
    v_mul_f32 v54, s50, v157
    v_exp_f32 v53, v53
    v_exp_f32 v54, v54
    v_cmp_lt_f32 vcc, 0, v156
    v_cmp_lt_f32 s[52:53], 0, v157
    v_add_f32 v55, 1.0, v156
    v_add_f32 v56, 1.0, v157
    v_cndmask_b32 v156, v53, v55, vcc
    v_cndmask_b32 v157, v54, v56, s[52:53]
    v_cvt_pk_bf16_f32 v52, v156, v157
    v_lshlrev_b32 v156, 16, v52
    v_and_b32 v157, 0xffff0000, v52
    v_add_f32 v156, s51, v156
    v_add_f32 v157, s51, v157
    v_cvt_pk_bf16_f32 v78, v156, v157
    v_cvt_pk_bf16_f32 v52, v158, v159
    v_lshlrev_b32 v158, 16, v52
    v_and_b32 v159, 0xffff0000, v52
    v_mul_f32 v53, s50, v158
    v_mul_f32 v54, s50, v159
    v_exp_f32 v53, v53
    v_exp_f32 v54, v54
    v_cmp_lt_f32 vcc, 0, v158
    v_cmp_lt_f32 s[52:53], 0, v159
    v_add_f32 v55, 1.0, v158
    v_add_f32 v56, 1.0, v159
    v_cndmask_b32 v158, v53, v55, vcc
    v_cndmask_b32 v159, v54, v56, s[52:53]
    v_cvt_pk_bf16_f32 v52, v158, v159
    v_lshlrev_b32 v158, 16, v52
    v_and_b32 v159, 0xffff0000, v52
    v_add_f32 v158, s51, v158
    v_add_f32 v159, s51, v159
    v_cvt_pk_bf16_f32 v79, v158, v159
    buffer_store_dwordx4 v[76:79], v7, s[20:23], s55 offen offset:1024 sc1
    v_mov_b32 v28, s40
    v_mov_b32 v29, s41
    s_waitcnt vmcnt(4)
    s_mov_b64 exec, 0x1
    buffer_store_dwordx2 v[28:29], v33, s[20:23], s54 offen sc1
    s_mov_b64 exec, -1
    s_lshl_b32 s42, s4, 2
    s_lshr_b32 s43, s5, 1
    s_add_u32 s42, s42, s43
    s_mul_i32 s42, s42, 4352
    s_and_b32 s43, s5, 1
    s_lshl_b32 s43, s43, 2
    s_add_u32 s43, s43, s3
    s_lshl_b32 s43, s43, 3
    s_add_u32 s42, s42, s43
    s_add_u32 s42, s42, 0x90000
    v_mov_b32 v0, s40
    v_mov_b32 v1, s41
    v_mov_b32 v21, 0
    s_waitcnt vmcnt(1)
    s_mov_b64 exec, 1
    buffer_store_dwordx2 v[0:1], v21, s[20:23], s42 offen sc1
    s_mov_b64 exec, -1
    s_mov_b32 s26, s40
    s_mov_b32 s27, s41
    s_mov_b32 s31, 1
    s_and_b32 s28, s6, 3
    s_lshl_b32 s28, s28, 3
    s_and_b32 s42, s7, 7
    s_or_b32 s28, s28, s42
    s_lshr_b32 s29, s7, 3
    s_and_b32 s30, s3, 3
    s_mov_b32 s36, s76
    s_and_b32 s37, s77, 0xffff
    s_mov_b32 s38, 0x800000
    s_mov_b32 s39, 0x00020000
G10B_COMMON:
    v_lshrrev_b32 v3, 4, v2
    v_and_b32 v4, 15, v2
    v_lshlrev_b32 v10, 4, v2
    s_lshl_b32 s42, s28, 6
    s_lshl_b32 s43, s31, 4
    s_add_u32 s42, s42, s43
    v_add_u32 v5, s42, v4
    s_lshl_b32 s42, s29, 7
    s_lshl_b32 s43, s30, 5
    s_add_u32 s42, s42, s43
    v_lshl_add_u32 v7, v3, 2, s42
    v_lshlrev_b32 v6, 10, v5
    v_add_u32 v6, v6, v7
    v_lshlrev_b32 v6, 2, v6
    s_lshl_b32 s42, s31, 2
    s_add_u32 s42, s42, s30
    s_lshl_b32 s42, s42, 12
    v_add_u32 v12, s42, v10
    s_xor_b32 s42, s42, 0x4000
    v_add_u32 v11, s42, v10
    v_lshrrev_b32 v16, 2, v2
    v_and_b32 v16, 3, v16
    v_lshl_add_u32 v17, v3, 2, v16
    v_lshlrev_b32 v17, 7, v17
    v_and_b32 v18, 3, v2
    v_lshl_add_u32 v17, v18, 3, v17
    s_lshr_b32 s42, s30, 1
    s_lshl_b32 s42, s42, 16
    s_lshl_b32 s43, s31, 15
    s_add_u32 s42, s42, s43
    s_add_u32 s42, s42, 32768
    v_add_u32 v17, s42, v17
    v_lshrrev_b32 v16, 1, v16
    v_and_b32 v18, 1, v3
    v_lshl_add_u32 v16, v18, 1, v16
    s_and_b32 s42, s30, 1
    s_lshl_b32 s42, s42, 1
    v_xor_b32 v16, s42, v16
    v_lshl_add_u32 v13, v16, 5, v17
    v_xor_b32 v16, 1, v16
    v_lshl_add_u32 v14, v16, 5, v17
    s_lshl_b32 s42, s3, 13
    s_add_u32 s42, s42, 32768
    v_add_u32 v15, s42, v10
    s_lshl_b32 s42, s31, 15
    s_add_u32 s42, s42, 32768
    s_lshl_b32 s43, s31, 10
    s_add_u32 s44, s42, s43
    s_xor_b32 s42, s44, 1024
    v_add_u32 v8, s44, v10
    v_add_u32 v9, s42, v10
    v_lshlrev_b32 v7, 3, v2
    v_and_b32 v16, 3, v4
    v_lshl_add_u32 v16, v16, 2, v3
    v_lshlrev_b32 v16, 4, v16
    v_and_b32 v16, 3, v4
    v_lshlrev_b32 v16, 11, v16
    v_lshl_add_u32 v16, v3, 4, v16
    v_lshlrev_b32 v17, 2, v2
    s_lshl_b32 s42, s3, 13
    s_add_u32 s54, s42, 0x100000
    s_add_u32 s55, s54, 4096
    s_mul_i32 s42, s3, 4352
    s_add_u32 s49, s42, 0x300000
    s_lshl_b32 s42, s30, 12
    v_add_u32 v22, s42, v7
    s_lshl_b32 s42, s28, 16
    s_lshl_b32 s43, s3, 13
    s_add_u32 s32, s42, s43
    s_add_u32 s32, s32, 0xc00000
    s_lshr_b32 s42, s28, 1
    s_lshl_b32 s42, s42, 2
    s_lshr_b32 s43, s3, 1
    s_add_u32 s42, s42, s43
    s_mul_i32 s42, s42, 4352
    s_and_b32 s43, s3, 1
    s_lshl_b32 s43, s43, 5
    s_add_u32 s42, s42, s43
    s_add_u32 s48, s42, 0x90000
    s_mov_b32 s47, 0
    s_mov_b32 s34, 0
    s_cmp_lg_u32 s31, 0
    s_cbranch_scc1 G10W_3
    s_waitcnt vmcnt(0)
G10W_3:
    s_barrier
    s_mov_b64 exec, 0xf
    buffer_load_dwordx2 v[0:1], v7, s[20:23], s48 offen sc1
    s_mov_b64 exec, -1
    buffer_load_dwordx2 v[18:19], v7, s[20:23], s49 offen sc1
    ds_read_b64_tr_b16 v[192:193], v13 offset:0
    ds_read_b64_tr_b16 v[194:195], v13 offset:2048
    ds_read_b64_tr_b16 v[196:197], v14 offset:0
    ds_read_b64_tr_b16 v[198:199], v14 offset:2048
    ds_read_b64_tr_b16 v[200:201], v13 offset:4096
    ds_read_b64_tr_b16 v[202:203], v13 offset:6144
    ds_read_b64_tr_b16 v[204:205], v14 offset:4096
    ds_read_b64_tr_b16 v[206:207], v14 offset:6144
    ds_read_b64_tr_b16 v[208:209], v13 offset:8192
    ds_read_b64_tr_b16 v[210:211], v13 offset:10240
    ds_read_b64_tr_b16 v[212:213], v14 offset:8192
    ds_read_b64_tr_b16 v[214:215], v14 offset:10240
    ds_read_b64_tr_b16 v[216:217], v13 offset:12288
    ds_read_b64_tr_b16 v[218:219], v13 offset:14336
    ds_read_b64_tr_b16 v[220:221], v14 offset:12288
    ds_read_b64_tr_b16 v[222:223], v14 offset:14336
    ds_read_b64_tr_b16 v[224:225], v13 offset:16384
    ds_read_b64_tr_b16 v[226:227], v13 offset:18432
    ds_read_b64_tr_b16 v[228:229], v14 offset:16384
    ds_read_b64_tr_b16 v[230:231], v14 offset:18432
    ds_read_b64_tr_b16 v[232:233], v13 offset:20480
    ds_read_b64_tr_b16 v[234:235], v13 offset:22528
    ds_read_b64_tr_b16 v[236:237], v14 offset:20480
    ds_read_b64_tr_b16 v[238:239], v14 offset:22528
    ds_read_b64_tr_b16 v[240:241], v13 offset:24576
    ds_read_b64_tr_b16 v[242:243], v13 offset:26624
    ds_read_b64_tr_b16 v[244:245], v14 offset:24576
    ds_read_b64_tr_b16 v[246:247], v14 offset:26624
    ds_read_b64_tr_b16 v[248:249], v13 offset:28672
    ds_read_b64_tr_b16 v[250:251], v13 offset:30720
    ds_read_b64_tr_b16 v[252:253], v14 offset:28672
    ds_read_b64_tr_b16 v[254:255], v14 offset:30720
    s_waitcnt lgkmcnt(0)
    s_barrier
    s_branch G10B_C
G10B_L0:
    s_mov_b64 exec, 0xf
    buffer_load_dwordx2 v[0:1], v7, s[20:23], s48 offen sc1
    s_mov_b64 exec, -1
    buffer_load_dwordx2 v[18:19], v7, s[20:23], s49 offen sc1
G10B_C:
    s_waitcnt vmcnt(0)
    v_cmp_eq_u32 vcc, s26, v0
    v_cmp_eq_u32 s[52:53], s27, v1
    s_and_b32 s42, vcc_lo, s52
    s_and_b32 s42, s42, 0xf
    s_cmp_eq_u32 s42, 0xf
    s_cbranch_scc1 G10B_Q
    s_add_u32 s47, s47, 1
    s_cmp_ge_u32 s47, 0x40000
    s_cbranch_scc1 G10B_Q
    s_sleep 6
    s_branch G10B_L0
G10B_Q:
    buffer_load_dwordx4 v[32:35], v10, s[20:23], s32 offen offset:0 sc1
    buffer_load_dwordx4 v[40:43], v10, s[20:23], s32 offen offset:2048 sc1
    s_add_u32 s46, s32, 4096
    buffer_load_dwordx4 v[48:51], v10, s[20:23], s46 offen offset:0 sc1
    buffer_load_dwordx4 v[56:59], v10, s[20:23], s46 offen offset:2048 sc1
    s_branch G10B_KC
G10B_KL:
    buffer_load_dwordx2 v[18:19], v7, s[20:23], s49 offen sc1
    s_waitcnt vmcnt(0)
G10B_KC:
    v_cmp_eq_u32 vcc, s26, v18
    v_cmp_eq_u32 s[52:53], s27, v19
    s_and_b64 s[44:45], vcc, s[52:53]
    s_cmp_eq_u64 s[44:45], -1
    s_cbranch_scc1 G10B_KO
    s_add_u32 s47, s47, 1
    s_cmp_ge_u32 s47, 0x40000
    s_cbranch_scc1 G10B_KO
    s_sleep 6
    s_branch G10B_KL
G10B_KO:
    buffer_load_dwordx4 v[80:83], v16, s[20:23], s54 offen offset:1024 sc1
    buffer_load_dword v64, v17, s[20:23], s54 offen offset:0 sc1
    buffer_load_dword v65, v17, s[20:23], s54 offen offset:256 sc1
    buffer_load_dword v66, v17, s[20:23], s54 offen offset:512 sc1
    buffer_load_dword v67, v17, s[20:23], s54 offen offset:768 sc1
    buffer_load_dword v68, v17, s[20:23], s54 offen offset:2048 sc1
    buffer_load_dword v69, v17, s[20:23], s54 offen offset:2304 sc1
    buffer_load_dword v70, v17, s[20:23], s54 offen offset:2560 sc1
    buffer_load_dword v71, v17, s[20:23], s54 offen offset:2816 sc1
    buffer_load_dword v72, v17, s[20:23], s55 offen offset:0 sc1
    buffer_load_dword v73, v17, s[20:23], s55 offen offset:256 sc1
    buffer_load_dword v74, v17, s[20:23], s55 offen offset:512 sc1
    buffer_load_dword v75, v17, s[20:23], s55 offen offset:768 sc1
    buffer_load_dword v76, v17, s[20:23], s55 offen offset:2048 sc1
    buffer_load_dword v77, v17, s[20:23], s55 offen offset:2304 sc1
    buffer_load_dword v78, v17, s[20:23], s55 offen offset:2560 sc1
    buffer_load_dword v79, v17, s[20:23], s55 offen offset:2816 sc1
    buffer_load_dwordx4 v[36:39], v10, s[20:23], s32 offen offset:1024 sc1
    buffer_load_dwordx4 v[44:47], v10, s[20:23], s32 offen offset:3072 sc1
    s_add_u32 s46, s32, 4096
    buffer_load_dwordx4 v[52:55], v10, s[20:23], s46 offen offset:1024 sc1
    buffer_load_dwordx4 v[60:63], v10, s[20:23], s46 offen offset:3072 sc1
    s_waitcnt vmcnt(4)
    v_cvt_pk_bf16_f32 v80, v80, v81
    v_cvt_pk_bf16_f32 v81, v82, v83
    v_cvt_pk_bf16_f32 v64, v64, v65
    v_cvt_pk_bf16_f32 v65, v66, v67
    v_cvt_pk_bf16_f32 v68, v68, v69
    v_cvt_pk_bf16_f32 v69, v70, v71
    v_cvt_pk_bf16_f32 v72, v72, v73
    v_cvt_pk_bf16_f32 v73, v74, v75
    v_cvt_pk_bf16_f32 v76, v76, v77
    v_cvt_pk_bf16_f32 v77, v78, v79
    s_nop 1
    s_mov_b32 s44, 0xaaaaaaaa
    s_mov_b32 s45, 0xaaaaaaaa
    v_mov_b32_dpp v92, v80 row_newbcast:0 row_mask:0xf bank_mask:0xf
    v_mov_b32_dpp v93, v81 row_newbcast:0 row_mask:0xf bank_mask:0xf
    v_cndmask_b32 v84, v92, 0, s[44:45]
    v_cndmask_b32 v85, v93, 0, s[44:45]
    v_cndmask_b32 v86, 0, v92, s[44:45]
    v_cndmask_b32 v87, 0, v93, s[44:45]
    v_mov_b32_dpp v92, v80 row_newbcast:1 row_mask:0xf bank_mask:0xf
    v_mov_b32_dpp v93, v81 row_newbcast:1 row_mask:0xf bank_mask:0xf
    v_cndmask_b32 v88, v92, 0, s[44:45]
    v_cndmask_b32 v89, v93, 0, s[44:45]
    v_cndmask_b32 v90, 0, v92, s[44:45]
    v_cndmask_b32 v91, 0, v93, s[44:45]
    v_mfma_f32_16x16x16_bf16 v[96:99], v[64:65], v[32:33], 0
    v_mfma_f32_16x16x16_bf16 v[100:103], v[64:65], v[34:35], 0
    v_mfma_f32_16x16x16_bf16 v[104:107], v[68:69], v[40:41], 0
    v_mfma_f32_16x16x16_bf16 v[108:111], v[68:69], v[42:43], 0
    v_mfma_f32_16x16x32_bf16 v[112:115], v[84:87], v[32:35], 0
    v_mfma_f32_16x16x32_bf16 v[116:119], v[88:91], v[40:43], 0
    v_mov_b32_dpp v92, v80 row_newbcast:2 row_mask:0xf bank_mask:0xf
    v_mov_b32_dpp v93, v81 row_newbcast:2 row_mask:0xf bank_mask:0xf
    v_cndmask_b32 v16, v92, 0, s[44:45]
    v_cndmask_b32 v17, v93, 0, s[44:45]
    v_cndmask_b32 v18, 0, v92, s[44:45]
    v_cndmask_b32 v19, 0, v93, s[44:45]
    v_mov_b32_dpp v92, v80 row_newbcast:3 row_mask:0xf bank_mask:0xf
    v_mov_b32_dpp v93, v81 row_newbcast:3 row_mask:0xf bank_mask:0xf
    v_cndmask_b32 v20, v92, 0, s[44:45]
    v_cndmask_b32 v21, v93, 0, s[44:45]
    v_cndmask_b32 v22, 0, v92, s[44:45]
    v_cndmask_b32 v23, 0, v93, s[44:45]
    v_cvt_pk_bf16_f32 v24, v96, v97
    v_cvt_pk_bf16_f32 v25, v98, v99
    v_cvt_pk_bf16_f32 v26, v100, v101
    v_cvt_pk_bf16_f32 v27, v102, v103
    v_cvt_pk_bf16_f32 v28, v104, v105
    v_cvt_pk_bf16_f32 v29, v106, v107
    v_cvt_pk_bf16_f32 v30, v108, v109
    v_cvt_pk_bf16_f32 v31, v110, v111
    v_mfma_f32_16x16x16_bf16 v[120:123], v[72:73], v[48:49], 0
    v_cvt_pk_bf16_f32 v114, v112, v113
    v_cvt_pk_bf16_f32 v118, v116, v117
    v_lshlrev_b32 v112, 16, v114
    v_and_b32 v113, 0xffff0000, v114
    v_lshlrev_b32 v116, 16, v118
    v_and_b32 v117, 0xffff0000, v118
    v_add_f32 v112, s51, v112
    v_add_f32 v113, s51, v113
    v_mfma_f32_16x16x16_bf16 v[124:127], v[72:73], v[50:51], 0
    v_add_f32 v116, s51, v116
    v_add_f32 v117, s51, v117
    v_cvt_pk_bf16_f32 v114, v112, v113
    v_cvt_pk_bf16_f32 v118, v116, v117
    v_lshlrev_b32 v112, 16, v114
    v_and_b32 v113, 0xffff0000, v114
    v_lshlrev_b32 v116, 16, v118
    v_and_b32 v117, 0xffff0000, v118
    v_mfma_f32_16x16x16_bf16 v[128:131], v[76:77], v[56:57], 0
    v_rcp_f32 v114, v112
    v_rcp_f32 v115, v113
    v_rcp_f32 v118, v116
    v_rcp_f32 v119, v117
    v_lshlrev_b32 v96, 16, v24
    v_and_b32 v97, 0xffff0000, v24
    v_lshlrev_b32 v98, 16, v25
    v_and_b32 v99, 0xffff0000, v25
    v_mfma_f32_16x16x16_bf16 v[132:135], v[76:77], v[58:59], 0
    v_lshlrev_b32 v100, 16, v26
    v_and_b32 v101, 0xffff0000, v26
    v_lshlrev_b32 v102, 16, v27
    v_and_b32 v103, 0xffff0000, v27
    v_lshlrev_b32 v104, 16, v28
    v_and_b32 v105, 0xffff0000, v28
    v_lshlrev_b32 v106, 16, v29
    v_and_b32 v107, 0xffff0000, v29
    v_mfma_f32_16x16x32_bf16 v[136:139], v[16:19], v[48:51], 0
    v_lshlrev_b32 v108, 16, v30
    v_and_b32 v109, 0xffff0000, v30
    v_lshlrev_b32 v110, 16, v31
    v_and_b32 v111, 0xffff0000, v31
    v_mul_f32 v96, v96, v114
    v_mul_f32 v97, v97, v114
    v_mul_f32 v98, v98, v114
    v_mul_f32 v99, v99, v114
    v_mfma_f32_16x16x32_bf16 v[140:143], v[20:23], v[56:59], 0
    v_mul_f32 v100, v100, v115
    v_mul_f32 v101, v101, v115
    v_mul_f32 v102, v102, v115
    v_mul_f32 v103, v103, v115
    v_mul_f32 v104, v104, v118
    v_mul_f32 v105, v105, v118
    v_mul_f32 v106, v106, v118
    v_mul_f32 v107, v107, v118
    v_mul_f32 v108, v108, v119
    v_mul_f32 v109, v109, v119
    v_mul_f32 v110, v110, v119
    v_mul_f32 v111, v111, v119
    v_cvt_pk_bf16_f32 v32, v96, v97
    v_cvt_pk_bf16_f32 v33, v98, v99
    v_cvt_pk_bf16_f32 v40, v100, v101
    v_cvt_pk_bf16_f32 v41, v102, v103
    v_cvt_pk_bf16_f32 v34, v104, v105
    v_cvt_pk_bf16_f32 v35, v106, v107
    v_cvt_pk_bf16_f32 v42, v108, v109
    v_cvt_pk_bf16_f32 v43, v110, v111
    v_cvt_pk_bf16_f32 v24, v120, v121
    v_cvt_pk_bf16_f32 v25, v122, v123
    v_cvt_pk_bf16_f32 v26, v124, v125
    v_cvt_pk_bf16_f32 v27, v126, v127
    v_cvt_pk_bf16_f32 v28, v128, v129
    v_cvt_pk_bf16_f32 v29, v130, v131
    v_cvt_pk_bf16_f32 v30, v132, v133
    v_cvt_pk_bf16_f32 v31, v134, v135
    v_cvt_pk_bf16_f32 v138, v136, v137
    v_cvt_pk_bf16_f32 v142, v140, v141
    v_lshlrev_b32 v136, 16, v138
    v_and_b32 v137, 0xffff0000, v138
    v_lshlrev_b32 v140, 16, v142
    v_and_b32 v141, 0xffff0000, v142
    v_add_f32 v136, s51, v136
    v_add_f32 v137, s51, v137
    v_add_f32 v140, s51, v140
    v_add_f32 v141, s51, v141
    v_cvt_pk_bf16_f32 v138, v136, v137
    v_cvt_pk_bf16_f32 v142, v140, v141
    v_lshlrev_b32 v136, 16, v138
    v_and_b32 v137, 0xffff0000, v138
    v_lshlrev_b32 v140, 16, v142
    v_and_b32 v141, 0xffff0000, v142
    v_rcp_f32 v138, v136
    v_rcp_f32 v139, v137
    v_rcp_f32 v142, v140
    v_rcp_f32 v143, v141
    v_lshlrev_b32 v120, 16, v24
    v_and_b32 v121, 0xffff0000, v24
    v_lshlrev_b32 v122, 16, v25
    v_and_b32 v123, 0xffff0000, v25
    v_lshlrev_b32 v124, 16, v26
    v_and_b32 v125, 0xffff0000, v26
    v_lshlrev_b32 v126, 16, v27
    v_and_b32 v127, 0xffff0000, v27
    v_lshlrev_b32 v128, 16, v28
    v_and_b32 v129, 0xffff0000, v28
    v_lshlrev_b32 v130, 16, v29
    v_and_b32 v131, 0xffff0000, v29
    v_lshlrev_b32 v132, 16, v30
    v_and_b32 v133, 0xffff0000, v30
    v_lshlrev_b32 v134, 16, v31
    v_and_b32 v135, 0xffff0000, v31
    v_mul_f32 v120, v120, v138
    v_mul_f32 v121, v121, v138
    v_mul_f32 v122, v122, v138
    v_mul_f32 v123, v123, v138
    v_mul_f32 v124, v124, v139
    v_mul_f32 v125, v125, v139
    v_mul_f32 v126, v126, v139
    v_mul_f32 v127, v127, v139
    v_mul_f32 v128, v128, v142
    v_mul_f32 v129, v129, v142
    v_mul_f32 v130, v130, v142
    v_mul_f32 v131, v131, v142
    v_mul_f32 v132, v132, v143
    v_mul_f32 v133, v133, v143
    v_mul_f32 v134, v134, v143
    v_mul_f32 v135, v135, v143
    v_cvt_pk_bf16_f32 v48, v120, v121
    v_cvt_pk_bf16_f32 v49, v122, v123
    v_cvt_pk_bf16_f32 v56, v124, v125
    v_cvt_pk_bf16_f32 v57, v126, v127
    v_cvt_pk_bf16_f32 v50, v128, v129
    v_cvt_pk_bf16_f32 v51, v130, v131
    v_cvt_pk_bf16_f32 v58, v132, v133
    v_cvt_pk_bf16_f32 v59, v134, v135
    ds_write_b128 v15, v[32:35] offset:0
    ds_write_b128 v15, v[40:43] offset:1024
    ds_write_b128 v15, v[48:51] offset:4096
    ds_write_b128 v15, v[56:59] offset:5120
    v_add_u32 v5, 0x20000, v6
    s_waitcnt lgkmcnt(0)
    s_barrier
    ds_read_b128 v[176:179], v8 offset:0
    ds_read_b128 v[180:183], v9 offset:0
    ds_read_b128 v[184:187], v8 offset:4096
    ds_read_b128 v[188:191], v9 offset:4096
    ds_read_b128 v[160:163], v8 offset:8192
    ds_read_b128 v[164:167], v9 offset:8192
    ds_read_b128 v[168:171], v8 offset:12288
    ds_read_b128 v[172:175], v9 offset:12288
    ds_read_b128 v[32:35], v8 offset:16384
    ds_read_b128 v[40:43], v9 offset:16384
    ds_read_b128 v[48:51], v8 offset:20480
    ds_read_b128 v[56:59], v9 offset:20480
    s_waitcnt vmcnt(0)
    v_mfma_f32_16x16x16_bf16 v[96:99], v[64:65], v[36:37], 0
    v_mfma_f32_16x16x16_bf16 v[100:103], v[64:65], v[38:39], 0
    v_mfma_f32_16x16x16_bf16 v[104:107], v[68:69], v[44:45], 0
    v_mfma_f32_16x16x16_bf16 v[108:111], v[68:69], v[46:47], 0
    v_mfma_f32_16x16x32_bf16 v[112:115], v[84:87], v[36:39], 0
    v_mfma_f32_16x16x32_bf16 v[116:119], v[88:91], v[44:47], 0
    s_waitcnt lgkmcnt(10)
    v_mfma_f32_16x16x32_bf16 v[144:147], v[192:195], v[176:179], 0
    v_mfma_f32_16x16x32_bf16 v[148:151], v[196:199], v[176:179], 0
    v_mfma_f32_16x16x32_bf16 v[152:155], v[192:195], v[180:183], 0
    v_mfma_f32_16x16x32_bf16 v[156:159], v[196:199], v[180:183], 0
    ds_read_b128 v[176:179], v8 offset:24576
    ds_read_b128 v[180:183], v9 offset:24576
    s_nop 1
    v_cvt_pk_bf16_f32 v24, v96, v97
    v_cvt_pk_bf16_f32 v25, v98, v99
    v_cvt_pk_bf16_f32 v26, v100, v101
    v_cvt_pk_bf16_f32 v27, v102, v103
    s_waitcnt lgkmcnt(10)
    v_cvt_pk_bf16_f32 v28, v104, v105
    v_cvt_pk_bf16_f32 v29, v106, v107
    v_cvt_pk_bf16_f32 v30, v108, v109
    v_mfma_f32_16x16x32_bf16 v[144:147], v[200:203], v[184:187], v[144:147]
    v_cvt_pk_bf16_f32 v31, v110, v111
    v_mfma_f32_16x16x16_bf16 v[120:123], v[72:73], v[52:53], 0
    v_cvt_pk_bf16_f32 v114, v112, v113
    v_cvt_pk_bf16_f32 v118, v116, v117
    v_mfma_f32_16x16x32_bf16 v[148:151], v[204:207], v[184:187], v[148:151]
    v_lshlrev_b32 v112, 16, v114
    v_and_b32 v113, 0xffff0000, v114
    v_lshlrev_b32 v116, 16, v118
    v_and_b32 v117, 0xffff0000, v118
    v_mfma_f32_16x16x32_bf16 v[152:155], v[200:203], v[188:191], v[152:155]
    v_add_f32 v112, s51, v112
    v_add_f32 v113, s51, v113
    v_mfma_f32_16x16x16_bf16 v[124:127], v[72:73], v[54:55], 0
    v_add_f32 v116, s51, v116
    v_mfma_f32_16x16x32_bf16 v[156:159], v[204:207], v[188:191], v[156:159]
    v_add_f32 v117, s51, v117
    v_cvt_pk_bf16_f32 v114, v112, v113
    v_cvt_pk_bf16_f32 v118, v116, v117
    ds_read_b128 v[184:187], v8 offset:28672
    v_lshlrev_b32 v112, 16, v114
    v_and_b32 v113, 0xffff0000, v114
    v_lshlrev_b32 v116, 16, v118
    v_and_b32 v117, 0xffff0000, v118
    ds_read_b128 v[188:191], v9 offset:28672
    v_mfma_f32_16x16x16_bf16 v[128:131], v[76:77], v[60:61], 0
    v_rcp_f32 v114, v112
    v_rcp_f32 v115, v113
    v_rcp_f32 v118, v116
    s_waitcnt lgkmcnt(10)
    v_rcp_f32 v119, v117
    v_lshlrev_b32 v96, 16, v24
    v_and_b32 v97, 0xffff0000, v24
    v_lshlrev_b32 v98, 16, v25
    v_mfma_f32_16x16x32_bf16 v[144:147], v[208:211], v[160:163], v[144:147]
    v_and_b32 v99, 0xffff0000, v25
    v_mfma_f32_16x16x16_bf16 v[132:135], v[76:77], v[62:63], 0
    v_lshlrev_b32 v100, 16, v26
    v_mfma_f32_16x16x32_bf16 v[148:151], v[212:215], v[160:163], v[148:151]
    v_and_b32 v101, 0xffff0000, v26
    v_lshlrev_b32 v102, 16, v27
    v_and_b32 v103, 0xffff0000, v27
    v_lshlrev_b32 v104, 16, v28
    v_mfma_f32_16x16x32_bf16 v[152:155], v[208:211], v[164:167], v[152:155]
    v_and_b32 v105, 0xffff0000, v28
    v_lshlrev_b32 v106, 16, v29
    v_and_b32 v107, 0xffff0000, v29
    v_mfma_f32_16x16x32_bf16 v[136:139], v[16:19], v[52:55], 0
    v_mfma_f32_16x16x32_bf16 v[156:159], v[212:215], v[164:167], v[156:159]
    v_lshlrev_b32 v108, 16, v30
    v_and_b32 v109, 0xffff0000, v30
    v_lshlrev_b32 v110, 16, v31
    v_and_b32 v111, 0xffff0000, v31
    s_waitcnt lgkmcnt(8)
    v_mul_f32 v96, v96, v114
    v_mul_f32 v97, v97, v114
    v_mul_f32 v98, v98, v114
    v_mfma_f32_16x16x32_bf16 v[144:147], v[216:219], v[168:171], v[144:147]
    v_mul_f32 v99, v99, v114
    v_mfma_f32_16x16x32_bf16 v[140:143], v[20:23], v[60:63], 0
    v_mul_f32 v100, v100, v115
    v_mul_f32 v101, v101, v115
    v_mfma_f32_16x16x32_bf16 v[148:151], v[220:223], v[168:171], v[148:151]
    v_mul_f32 v102, v102, v115
    v_mul_f32 v103, v103, v115
    v_mul_f32 v104, v104, v118
    v_mul_f32 v105, v105, v118
    v_mfma_f32_16x16x32_bf16 v[152:155], v[216:219], v[172:175], v[152:155]
    v_mul_f32 v106, v106, v118
    v_mul_f32 v107, v107, v118
    v_mul_f32 v108, v108, v119
    v_mul_f32 v109, v109, v119
    v_mfma_f32_16x16x32_bf16 v[156:159], v[220:223], v[172:175], v[156:159]
    v_mul_f32 v110, v110, v119
    v_mul_f32 v111, v111, v119
    v_cvt_pk_bf16_f32 v36, v96, v97
    s_waitcnt lgkmcnt(6)
    v_cvt_pk_bf16_f32 v37, v98, v99
    v_cvt_pk_bf16_f32 v44, v100, v101
    v_cvt_pk_bf16_f32 v45, v102, v103
    v_cvt_pk_bf16_f32 v38, v104, v105
    v_mfma_f32_16x16x32_bf16 v[144:147], v[224:227], v[32:35], v[144:147]
    v_cvt_pk_bf16_f32 v39, v106, v107
    v_cvt_pk_bf16_f32 v46, v108, v109
    v_cvt_pk_bf16_f32 v47, v110, v111
    v_cvt_pk_bf16_f32 v24, v120, v121
    v_mfma_f32_16x16x32_bf16 v[148:151], v[228:231], v[32:35], v[148:151]
    v_cvt_pk_bf16_f32 v25, v122, v123
    v_cvt_pk_bf16_f32 v26, v124, v125
    v_cvt_pk_bf16_f32 v27, v126, v127
    v_cvt_pk_bf16_f32 v28, v128, v129
    v_mfma_f32_16x16x32_bf16 v[152:155], v[224:227], v[40:43], v[152:155]
    v_cvt_pk_bf16_f32 v29, v130, v131
    v_cvt_pk_bf16_f32 v30, v132, v133
    v_cvt_pk_bf16_f32 v31, v134, v135
    v_mfma_f32_16x16x32_bf16 v[156:159], v[228:231], v[40:43], v[156:159]
    v_cvt_pk_bf16_f32 v138, v136, v137
    v_cvt_pk_bf16_f32 v142, v140, v141
    v_lshlrev_b32 v136, 16, v138
    v_and_b32 v137, 0xffff0000, v138
    s_waitcnt lgkmcnt(4)
    v_lshlrev_b32 v140, 16, v142
    v_and_b32 v141, 0xffff0000, v142
    v_add_f32 v136, s51, v136
    v_add_f32 v137, s51, v137
    v_mfma_f32_16x16x32_bf16 v[144:147], v[232:235], v[48:51], v[144:147]
    v_add_f32 v140, s51, v140
    v_add_f32 v141, s51, v141
    v_cvt_pk_bf16_f32 v138, v136, v137
    v_cvt_pk_bf16_f32 v142, v140, v141
    v_mfma_f32_16x16x32_bf16 v[148:151], v[236:239], v[48:51], v[148:151]
    v_lshlrev_b32 v136, 16, v138
    v_and_b32 v137, 0xffff0000, v138
    v_lshlrev_b32 v140, 16, v142
    v_mfma_f32_16x16x32_bf16 v[152:155], v[232:235], v[56:59], v[152:155]
    v_and_b32 v141, 0xffff0000, v142
    v_rcp_f32 v138, v136
    v_rcp_f32 v139, v137
    v_rcp_f32 v142, v140
    v_mfma_f32_16x16x32_bf16 v[156:159], v[236:239], v[56:59], v[156:159]
    v_rcp_f32 v143, v141
    v_lshlrev_b32 v120, 16, v24
    v_and_b32 v121, 0xffff0000, v24
    v_lshlrev_b32 v122, 16, v25
    s_waitcnt lgkmcnt(2)
    v_and_b32 v123, 0xffff0000, v25
    v_lshlrev_b32 v124, 16, v26
    v_and_b32 v125, 0xffff0000, v26
    v_lshlrev_b32 v126, 16, v27
    v_mfma_f32_16x16x32_bf16 v[144:147], v[240:243], v[176:179], v[144:147]
    v_and_b32 v127, 0xffff0000, v27
    v_lshlrev_b32 v128, 16, v28
    v_and_b32 v129, 0xffff0000, v28
    v_mfma_f32_16x16x32_bf16 v[148:151], v[244:247], v[176:179], v[148:151]
    v_lshlrev_b32 v130, 16, v29
    v_and_b32 v131, 0xffff0000, v29
    v_lshlrev_b32 v132, 16, v30
    v_and_b32 v133, 0xffff0000, v30
    v_mfma_f32_16x16x32_bf16 v[152:155], v[240:243], v[180:183], v[152:155]
    v_lshlrev_b32 v134, 16, v31
    v_and_b32 v135, 0xffff0000, v31
    v_mul_f32 v120, v120, v138
    v_mul_f32 v121, v121, v138
    v_mfma_f32_16x16x32_bf16 v[156:159], v[244:247], v[180:183], v[156:159]
    v_mul_f32 v122, v122, v138
    v_mul_f32 v123, v123, v138
    v_mul_f32 v124, v124, v139
    v_mul_f32 v125, v125, v139
    s_waitcnt lgkmcnt(0)
    v_mul_f32 v126, v126, v139
    v_mul_f32 v127, v127, v139
    v_mul_f32 v128, v128, v142
    v_mfma_f32_16x16x32_bf16 v[144:147], v[248:251], v[184:187], v[144:147]
    v_mul_f32 v129, v129, v142
    v_mul_f32 v130, v130, v142
    v_mul_f32 v131, v131, v142
    v_mul_f32 v132, v132, v143
    v_mfma_f32_16x16x32_bf16 v[148:151], v[252:255], v[184:187], v[148:151]
    v_mul_f32 v133, v133, v143
    v_mul_f32 v134, v134, v143
    v_mul_f32 v135, v135, v143
    v_cvt_pk_bf16_f32 v52, v120, v121
    v_mfma_f32_16x16x32_bf16 v[152:155], v[248:251], v[188:191], v[152:155]
    v_cvt_pk_bf16_f32 v53, v122, v123
    v_cvt_pk_bf16_f32 v60, v124, v125
    v_cvt_pk_bf16_f32 v61, v126, v127
    v_cvt_pk_bf16_f32 v54, v128, v129
    v_mfma_f32_16x16x32_bf16 v[156:159], v[252:255], v[188:191], v[156:159]
    v_cvt_pk_bf16_f32 v55, v130, v131
    v_cvt_pk_bf16_f32 v62, v132, v133
    v_cvt_pk_bf16_f32 v63, v134, v135
    ds_write_b128 v15, v[36:39] offset:2048
    ds_write_b128 v15, v[44:47] offset:3072
    ds_write_b128 v15, v[52:55] offset:6144
    ds_write_b128 v15, v[60:63] offset:7168
    s_nop 5
    ds_write_b128 v11, v[152:155] offset:0
    ds_write_b128 v11, v[156:159] offset:1024
    s_waitcnt lgkmcnt(0)
    s_barrier
    s_lshl_b32 s42, s29, 3
    s_or_b32 s42, s42, s3
    s_lshl_b32 s42, s42, 5
    s_or_b32 s42, s42, s28
    s_cmp_lg_u32 s42, 159
    s_cbranch_scc1 G10B_NOBUMP
    v_mov_b32 v0, s26
    v_mov_b32 v1, 0
    s_mov_b32 s46, 0x20100
    s_mov_b64 exec, 1
    buffer_store_dword v0, v1, s[20:23], s46 offen sc1
    s_mov_b64 exec, -1
G10B_NOBUMP:
    ds_read_b128 v[96:99], v12 offset:0
    ds_read_b128 v[100:103], v12 offset:1024
    ds_read_b128 v[108:111], v9 offset:2048
    ds_read_b128 v[116:119], v9 offset:6144
    ds_read_b128 v[124:127], v9 offset:10240
    ds_read_b128 v[132:135], v9 offset:14336
    ds_read_b128 v[140:143], v9 offset:18432
    ds_read_b128 v[180:183], v9 offset:22528
    ds_read_b128 v[188:191], v9 offset:26624
    ds_read_b128 v[36:39], v9 offset:30720
    ds_read_b128 v[104:107], v8 offset:2048
    ds_read_b128 v[112:115], v8 offset:6144
    ds_read_b128 v[120:123], v8 offset:10240
    ds_read_b128 v[128:131], v8 offset:14336
    ds_read_b128 v[136:139], v8 offset:18432
    ds_read_b128 v[176:179], v8 offset:22528
    ds_read_b128 v[184:187], v8 offset:26624
    ds_read_b128 v[32:35], v8 offset:30720
    s_waitcnt lgkmcnt(15)
    v_mfma_f32_16x16x32_bf16 v[168:171], v[192:195], v[108:111], 0
    v_mfma_f32_16x16x32_bf16 v[172:175], v[196:199], v[108:111], 0
    s_waitcnt lgkmcnt(14)
    v_add_f32 v96, v96, v144
    v_add_f32 v97, v97, v145
    v_mfma_f32_16x16x32_bf16 v[168:171], v[200:203], v[116:119], v[168:171]
    v_add_f32 v98, v98, v146
    v_mfma_f32_16x16x32_bf16 v[172:175], v[204:207], v[116:119], v[172:175]
    v_add_f32 v99, v99, v147
    s_waitcnt lgkmcnt(13)
    v_cvt_pk_bf16_f32 v24, v96, v97
    v_mfma_f32_16x16x32_bf16 v[168:171], v[208:211], v[124:127], v[168:171]
    v_cvt_pk_bf16_f32 v25, v98, v99
    v_mfma_f32_16x16x32_bf16 v[172:175], v[212:215], v[124:127], v[172:175]
    v_lshlrev_b32 v96, 16, v24
    s_waitcnt lgkmcnt(12)
    v_and_b32 v97, 0xffff0000, v24
    v_mfma_f32_16x16x32_bf16 v[168:171], v[216:219], v[132:135], v[168:171]
    v_lshlrev_b32 v98, 16, v25
    v_mfma_f32_16x16x32_bf16 v[172:175], v[220:223], v[132:135], v[172:175]
    v_and_b32 v99, 0xffff0000, v25
    s_waitcnt lgkmcnt(11)
    buffer_store_dwordx4 v[96:99], v6, s[36:39], 0 offen offset:2048 sc1
    v_mfma_f32_16x16x32_bf16 v[168:171], v[224:227], v[140:143], v[168:171]
    v_add_f32 v100, v100, v148
    v_mfma_f32_16x16x32_bf16 v[172:175], v[228:231], v[140:143], v[172:175]
    v_add_f32 v101, v101, v149
    s_waitcnt lgkmcnt(10)
    v_add_f32 v102, v102, v150
    v_mfma_f32_16x16x32_bf16 v[168:171], v[232:235], v[180:183], v[168:171]
    v_add_f32 v103, v103, v151
    v_mfma_f32_16x16x32_bf16 v[172:175], v[236:239], v[180:183], v[172:175]
    v_cvt_pk_bf16_f32 v24, v100, v101
    s_waitcnt lgkmcnt(9)
    v_cvt_pk_bf16_f32 v25, v102, v103
    v_mfma_f32_16x16x32_bf16 v[168:171], v[240:243], v[188:191], v[168:171]
    v_lshlrev_b32 v100, 16, v24
    v_mfma_f32_16x16x32_bf16 v[172:175], v[244:247], v[188:191], v[172:175]
    v_and_b32 v101, 0xffff0000, v24
    s_waitcnt lgkmcnt(8)
    v_lshlrev_b32 v102, 16, v25
    v_mfma_f32_16x16x32_bf16 v[168:171], v[248:251], v[36:39], v[168:171]
    v_and_b32 v103, 0xffff0000, v25
    v_mfma_f32_16x16x32_bf16 v[172:175], v[252:255], v[36:39], v[172:175]
    buffer_store_dwordx4 v[100:103], v6, s[36:39], 0 offen offset:2112 sc1
    s_waitcnt lgkmcnt(0)
    v_mfma_f32_16x16x32_bf16 v[160:163], v[192:195], v[104:107], 0
    v_mfma_f32_16x16x32_bf16 v[160:163], v[200:203], v[112:115], v[160:163]
    v_mfma_f32_16x16x32_bf16 v[160:163], v[208:211], v[120:123], v[160:163]
    v_mfma_f32_16x16x32_bf16 v[160:163], v[216:219], v[128:131], v[160:163]
    s_nop 5
    ds_write_b128 v11, v[168:171] offset:2048
    ds_write_b128 v11, v[172:175] offset:3072
    v_mfma_f32_16x16x32_bf16 v[160:163], v[224:227], v[136:139], v[160:163]
    v_mfma_f32_16x16x32_bf16 v[160:163], v[232:235], v[176:179], v[160:163]
    v_mfma_f32_16x16x32_bf16 v[160:163], v[240:243], v[184:187], v[160:163]
    v_mfma_f32_16x16x32_bf16 v[160:163], v[248:251], v[32:35], v[160:163]
    s_waitcnt lgkmcnt(0)
    s_barrier
    ds_read_b128 v[96:99], v12 offset:2048
    ds_read_b128 v[100:103], v12 offset:3072
    v_mfma_f32_16x16x32_bf16 v[164:167], v[196:199], v[104:107], 0
    v_mfma_f32_16x16x32_bf16 v[164:167], v[204:207], v[112:115], v[164:167]
    v_mfma_f32_16x16x32_bf16 v[164:167], v[212:215], v[120:123], v[164:167]
    v_mfma_f32_16x16x32_bf16 v[164:167], v[220:223], v[128:131], v[164:167]
    s_nop 3
    s_waitcnt lgkmcnt(1)
    v_mfma_f32_16x16x32_bf16 v[164:167], v[228:231], v[136:139], v[164:167]
    v_add_f32 v96, v96, v160
    v_add_f32 v97, v97, v161
    v_add_f32 v98, v98, v162
    v_add_f32 v99, v99, v163
    v_cvt_pk_bf16_f32 v24, v96, v97
    v_mfma_f32_16x16x32_bf16 v[164:167], v[236:239], v[176:179], v[164:167]
    v_cvt_pk_bf16_f32 v25, v98, v99
    v_lshlrev_b32 v96, 16, v24
    v_mfma_f32_16x16x32_bf16 v[164:167], v[244:247], v[184:187], v[164:167]
    v_and_b32 v97, 0xffff0000, v24
    v_lshlrev_b32 v98, 16, v25
    v_mfma_f32_16x16x32_bf16 v[164:167], v[252:255], v[32:35], v[164:167]
    v_and_b32 v99, 0xffff0000, v25
    buffer_store_dwordx4 v[96:99], v5, s[36:39], 0 offen offset:2048 sc1
    s_waitcnt lgkmcnt(0)
    s_nop 8
    v_add_f32 v100, v100, v164
    v_add_f32 v101, v101, v165
    v_add_f32 v102, v102, v166
    v_add_f32 v103, v103, v167
    v_cvt_pk_bf16_f32 v24, v100, v101
    v_cvt_pk_bf16_f32 v25, v102, v103
    v_lshlrev_b32 v100, 16, v24
    v_and_b32 v101, 0xffff0000, v24
    v_lshlrev_b32 v102, 16, v25
    v_and_b32 v103, 0xffff0000, v25
    buffer_store_dwordx4 v[100:103], v5, s[36:39], 0 offen offset:2112 sc1
    s_endpgm
CODE_END:
.section .rodata,"a"
.p2align 6
.amdhsa_kernel s5la_f1_kernel
  .amdhsa_next_free_vgpr 256
  .amdhsa_next_free_sgpr 102
  .amdhsa_accum_offset 256
  .amdhsa_group_segment_fixed_size 0
  .amdhsa_kernarg_size 120
  .amdhsa_user_sgpr_count 2
  .amdhsa_user_sgpr_kernarg_segment_ptr 1
  .amdhsa_system_sgpr_workgroup_id_x 1
.end_amdhsa_kernel
```
